```python
import torch

def _softmax(x, axis=-1):
    return torch.softmax(x, dim=axis)
def _gelu(x):
    return torch.nn.functional.gelu(x, approximate="tanh")
def _silu(x):
    return torch.nn.functional.silu(x)
def _sigmoid(x):
    return torch.sigmoid(x)
def _layernorm(x, axis=-1, eps=1e-5):
    m = x.mean(dim=axis, keepdim=True)
    v = x.var(dim=axis, keepdim=True, unbiased=False)
    return (x - m) / torch.sqrt(v + eps)
def _scatter_add(tgt, idx, src, axis=0):
    return tgt.clone().index_add_(axis, idx, src)
def _segment_sum(src, seg, n):
    out = torch.zeros((n,) + src.shape[1:], dtype=src.dtype)
    return out.index_add_(0, seg, src)
def _pad(x, pw):
    flat = tuple(v for pair in reversed(pw) for v in pair)
    return torch.nn.functional.pad(x, flat)

kernel_name = 'sequential_preLN__linear_attn_block__dense_activation_mish__prompt'

def setup_inputs():

    _w = (lambda a: (lambda t: t.to(torch.bfloat16) if t.is_floating_point() else t)(torch.as_tensor(a)))
    def _A_setup():
        B, S, D = 1, 2048, 512
        return {
            "x": _w((lambda *s: torch.randn(*s, dtype=torch.bfloat16) * 0.05)(B, S, D)),
            "wqkv": _w((lambda *s: torch.randn(*s, dtype=torch.bfloat16) * 0.05)(D, 3 * D)),
            "wo": _w((lambda *s: torch.randn(*s, dtype=torch.bfloat16) * 0.05)(D, D)),
        }
    _A_in = _A_setup()

    def _B_setup():
        B, S, D, F = 1, 2048, 512, 1376
        return {
            "x": _w((lambda *s: torch.randn(*s, dtype=torch.bfloat16) * 0.05)(B, S, D)),
            "w1": _w((lambda *s: torch.randn(*s, dtype=torch.bfloat16) * 0.8)(D, F) * (D ** -0.5)),
            "b1": _w((lambda *s: torch.randn(*s, dtype=torch.bfloat16) * 0.2)(F)),
            "w2": _w((lambda *s: torch.randn(*s, dtype=torch.bfloat16) * 0.1)(F, D) * (F ** -0.5)),
        }
    _B_in = _B_setup()

    return {
        "A_x": _A_in["x"],
        "A_wqkv": _A_in["wqkv"],
        "A_wo": _A_in["wo"],
        "B_x": _B_in["x"],
        "B_w1": _B_in["w1"],
        "B_b1": _B_in["b1"],
        "B_w2": _B_in["w2"],
    }

def reference(A_x, A_wqkv, A_wo, B_x, B_w1, B_b1, B_w2):
    def _A_ref(x, wqkv, wo):
        B, S, D = x.shape
        H = 32; Dh = D // H
        qkv = (lambda x, *d: x.permute(*d))((x @ wqkv).reshape(B, S, 3, H, Dh), 2, 0, 3, 1, 4)
        q, k, v = qkv[0], qkv[1], qkv[2]
        phi = lambda t: torch.where(t > 0, t + 1, torch.exp(t)) + 1e-6
        pq, pk = phi(q), phi(k)
        kv = torch.einsum("bhsd,bhse->bhde", pk, v)
        z = torch.einsum("bhsd->bhd", pk)
        num = torch.einsum("bhqd,bhde->bhqe", pq, kv)
        den = torch.einsum("bhqd,bhd->bhq", pq, z)[..., None] + 1e-6
        o = num / den
        return (lambda x, *d: x.permute(*d))(o, 0, 2, 1, 3).reshape(B, S, D) @ wo

    def _B_ref(x, w1, b1, w2):
        h = torch.einsum("bsd,df->bsf", x, w1) + b1
        sp = torch.log1p(torch.exp(-torch.abs(h))) + torch.where(h > 0, h, torch.zeros_like(h))
        act = h * torch.tanh(sp)
        return torch.einsum("bsf,fd->bsd", act, w2)

    x = A_x
    h = x + _A_ref(_layernorm(x, axis=-1), A_wqkv, A_wo)
    h2 = h + _B_ref(_layernorm(h, axis=-1), B_w1, B_b1, B_w2)
    return h2
```

```asm
; @launch grid=(256,1,1) block=(512,1,1) lds=163840
.amdgcn_target "amdgcn-amd-amdhsa--gfx950"
.text
.globl sequential_preLN__linear_attn_block__dense_activation_mish__prompt_kernel
.p2align 8
.type sequential_preLN__linear_attn_block__dense_activation_mish__prompt_kernel,@function
sequential_preLN__linear_attn_block__dense_activation_mish__prompt_kernel:
    s_cmp_ge_u32 s2, 256
    s_cbranch_scc1 KF_END
    s_load_dwordx4 s[4:7], s[0:1], 0
    s_load_dwordx4 s[8:11], s[0:1], 64
    s_load_dwordx2 s[50:51], s[0:1], 16
    s_load_dwordx4 s[68:71], s[0:1], 32
    s_load_dwordx4 s[72:75], s[0:1], 48
    v_lshrrev_b32 v4, 6, v0
    v_and_b32 v1, 63, v0
    v_readfirstlane_b32 s12, v4
    v_and_b32 v2, 15, v1
    v_lshrrev_b32 v3, 4, v1
    s_and_b32 s40, s2, 7
    s_lshr_b32 s17, s2, 3
    s_lshr_b32 s13, s40, 1
    s_lshl_b32 s13, s13, 3
    s_and_b32 s42, s17, 7
    s_add_u32 s13, s13, s42
    s_and_b32 s14, s40, 1
    s_lshl_b32 s14, s14, 2
    s_lshr_b32 s42, s17, 3
    s_add_u32 s14, s14, s42
    s_lshr_b32 s15, s12, 2
    s_and_b32 s16, s12, 3
    s_add_u32 s18, s17, s42
    s_and_b32 s18, s18, 7
    v_lshrrev_b32 v12, 3, v1
    s_lshl_b32 s40, s12, 3
    v_add_u32 v12, s40, v12
    v_and_b32 v14, 7, v1
    v_lshlrev_b32 v5, 4, v14
    v_lshl_add_u32 v5, v12, 10, v5
    s_and_b32 s41, s12, 1
    s_lshl_b32 s41, s41, 2
    v_add_u32 v13, s41, v3
    v_xor_b32 v13, v13, v14
    v_lshlrev_b32 v13, 4, v13
    v_lshl_add_u32 v7, v12, 7, v13
    v_mul_u32_u24 v12, 3072, v12
    v_and_b32 v13, 1, v3
    v_lshlrev_b32 v13, 1, v13
    v_add_u32 v13, s41, v13
    v_xor_b32 v13, v13, v14
    v_lshl_add_u32 v6, v13, 4, v12
    s_lshl_b32 s44, s13, 16
    s_lshl_b32 s45, s14, 7
    s_lshl_b32 s46, s12, 10
    s_waitcnt lgkmcnt(0)
    s_mov_b32 s20, s4
    s_and_b32 s21, s5, 0xffff
    s_mov_b32 s22, 2097152
    s_mov_b32 s23, 0x20000
    s_mov_b32 s24, s6
    s_and_b32 s25, s7, 0xffff
    s_mov_b32 s26, 1572864
    s_mov_b32 s27, 0x20000
    s_add_u32 s47, s18, 0
    s_and_b32 s47, s47, 7
    s_lshl_b32 s47, s47, 7
    s_add_u32 s47, s47, s44
    buffer_load_dwordx4 v[96:99], v5, s[20:23], s47 offen
    s_add_u32 s47, s18, 1
    s_and_b32 s47, s47, 7
    s_lshl_b32 s47, s47, 7
    s_add_u32 s47, s47, s44
    buffer_load_dwordx4 v[100:103], v5, s[20:23], s47 offen
    s_add_u32 s47, s18, 2
    s_and_b32 s47, s47, 7
    s_lshl_b32 s47, s47, 7
    s_add_u32 s47, s47, s44
    buffer_load_dwordx4 v[104:107], v5, s[20:23], s47 offen
    s_add_u32 s47, s18, 3
    s_and_b32 s47, s47, 7
    s_lshl_b32 s47, s47, 7
    s_add_u32 s47, s47, s44
    buffer_load_dwordx4 v[108:111], v5, s[20:23], s47 offen
    s_add_u32 s47, s18, 4
    s_and_b32 s47, s47, 7
    s_lshl_b32 s47, s47, 7
    s_add_u32 s47, s47, s44
    buffer_load_dwordx4 v[112:115], v5, s[20:23], s47 offen
    s_add_u32 s47, s18, 5
    s_and_b32 s47, s47, 7
    s_lshl_b32 s47, s47, 7
    s_add_u32 s47, s47, s44
    buffer_load_dwordx4 v[116:119], v5, s[20:23], s47 offen
    s_add_u32 s47, s18, 6
    s_and_b32 s47, s47, 7
    s_lshl_b32 s47, s47, 7
    s_add_u32 s47, s47, s44
    buffer_load_dwordx4 v[120:123], v5, s[20:23], s47 offen
    s_add_u32 s47, s18, 7
    s_and_b32 s47, s47, 7
    s_lshl_b32 s47, s47, 7
    s_add_u32 s47, s47, s44
    buffer_load_dwordx4 v[124:127], v5, s[20:23], s47 offen
    s_add_u32 s47, s18, 0
    s_and_b32 s47, s47, 7
    s_mul_i32 s49, s47, 196608
    s_add_u32 s49, s49, s45
    s_add_u32 m0, s46, 64512
    s_nop 0
    buffer_load_dwordx4 v6, s[24:27], s49 offen offset:1024 lds
    s_add_u32 s47, s18, 0
    s_and_b32 s47, s47, 7
    s_mul_i32 s49, s47, 196608
    s_add_u32 s49, s49, s45
    s_add_u32 m0, s46, 71680
    s_nop 0
    buffer_load_dwordx4 v6, s[24:27], s49 offen offset:2048 lds
    s_mov_b32 s32, s8
    s_and_b32 s33, s9, 0xffff
    s_mov_b32 s34, 256
    s_mov_b32 s35, 0x20000
    s_mov_b32 s28, s10
    s_and_b32 s29, s11, 0xffff
    s_mov_b32 s30, 10182656
    s_mov_b32 s31, 0x20000
    s_cmp_eq_u32 s12, 7
    s_cselect_b32 s38, 256, 0
    s_cmp_lt_u32 s2, 9
    s_cselect_b32 s38, s38, 0
    s_mov_b32 s36, s8
    s_and_b32 s37, s9, 0xffff
    s_mov_b32 s39, 0x20000
    s_mul_i32 s40, s2, 4352
    s_cmp_eq_u32 s2, 8
    s_cselect_b32 s40, 36864, s40
    s_add_u32 s56, s10, s40
    s_addc_u32 s57, s11, 0
    s_and_b32 s57, s57, 0xffff
    s_mov_b32 s58, 0
    s_mov_b32 s59, 0x20000
    s_mov_b32 s40, 10158080
    s_add_u32 s60, s10, s40
    s_addc_u32 s61, s11, 0
    s_and_b32 s61, s61, 0xffff
    s_mov_b32 s62, 0
    s_mov_b32 s63, 0x20000
    s_cmp_lg_u32 s38, 0
    s_cselect_b32 s58, 4352, 0
    s_cselect_b32 s62, 0x6000, 0
    s_cmp_eq_u32 s2, 8
    s_cselect_b32 s62, s62, 0
    s_cmp_lg_u32 s62, 0
    s_cselect_b32 s58, 5504, s58
    v_lshlrev_b32 v12, 4, v1
    v_mov_b32 v24, 0
    v_mov_b32 v25, 0
    v_mov_b32 v26, 0
    v_mov_b32 v27, 0
    s_mov_b32 s40, 4096
    buffer_store_dwordx4 v[24:27], v12, s[56:59], 0 offen offset:0 sc1
    buffer_store_dwordx4 v[24:27], v12, s[56:59], 0 offen offset:1024 sc1
    buffer_store_dwordx4 v[24:27], v12, s[56:59], 0 offen offset:2048 sc1
    buffer_store_dwordx4 v[24:27], v12, s[56:59], 0 offen offset:3072 sc1
    buffer_store_dwordx4 v[24:27], v12, s[56:59], s40 offen sc1
    buffer_store_dwordx4 v[24:27], v12, s[56:59], s40 offen offset:1024 sc1
    v_lshlrev_b32 v13, 8, v1
    buffer_store_dword v24, v13, s[60:63], 0 offen sc1
    s_mov_b32 s40, 0x4000
    buffer_store_dword v24, v13, s[60:63], s40 offen sc1
    v_lshlrev_b32 v15, 2, v1
    s_lshl_b32 s40, s2, 2
    v_mov_b32 v22, s40
    s_mov_b32 s76, s68
    s_and_b32 s77, s69, 0xffff
    s_mov_b32 s78, 1409024
    s_mov_b32 s79, 0x20000
    s_cmp_ge_u32 s2, 215
    s_cselect_b32 s78, 0, s78
    s_cmp_eq_u32 s12, 7
    s_cselect_b32 s78, 0, s78
    s_mul_i32 s52, s2, 1525
    s_lshr_b32 s52, s52, 16
    s_mul_i32 s53, s52, 43
    s_sub_u32 s53, s2, s53
    v_lshrrev_b32 v12, 2, v1
    v_mul_u32_u24 v12, 2752, v12
    v_and_b32 v13, 3, v1
    v_lshl_add_u32 v12, v13, 4, v12
    s_mul_i32 s40, s52, 7
    s_add_u32 s40, s40, s12
    s_mul_i32 s40, s40, 44032
    s_lshl_b32 s41, s53, 6
    s_add_u32 s40, s40, s41
    buffer_load_dwordx4 v[192:195], v12, s[76:79], s40 offen
    s_lshl_b32 s40, s15, 12
    v_lshrrev_b32 v12, 1, v2
    v_xor_b32 v12, v12, v3
    v_lshlrev_b32 v12, 4, v12
    v_lshl_add_u32 v12, v2, 7, v12
    v_add_u32 v8, s40, v12
    v_xor_b32 v9, 64, v8
    v_lshrrev_b32 v12, 2, v2
    v_lshl_add_u32 v13, v3, 3, v12
    v_lshlrev_b32 v13, 7, v13
    v_lshrrev_b32 v12, 1, v12
    v_and_b32 v14, 1, v3
    v_lshl_add_u32 v12, v14, 1, v12
    v_lshlrev_b32 v12, 1, v12
    v_bfe_u32 v14, v1, 1, 1
    s_lshl_b32 s40, s16, 1
    v_add_u32 v14, s40, v14
    v_xor_b32 v12, v12, v14
    v_lshl_add_u32 v13, v12, 4, v13
    v_and_b32 v12, 1, v1
    v_lshl_add_u32 v13, v12, 3, v13
    v_add_u32 v10, 65536, v13
    v_add_u32 v11, 114688, v13
    v_mov_b32 v16, 0x3f803f80
    v_mov_b32 v17, 0x3f803f80
    v_mov_b32 v18, 0x3f803f80
    v_mov_b32 v19, 0x3f803f80
    v_mov_b32 v32, 0
    v_mov_b32 v33, 0
    v_mov_b32 v34, 0
    v_mov_b32 v35, 0
    v_mov_b32 v36, 0
    v_mov_b32 v37, 0
    v_mov_b32 v38, 0
    v_mov_b32 v39, 0
    v_mov_b32 v40, 0
    v_mov_b32 v41, 0
    v_mov_b32 v42, 0
    v_mov_b32 v43, 0
    v_mov_b32 v44, 0
    v_mov_b32 v45, 0
    v_mov_b32 v46, 0
    v_mov_b32 v47, 0
    v_mov_b32 v48, 0
    v_mov_b32 v49, 0
    v_mov_b32 v50, 0
    v_mov_b32 v51, 0
    v_mov_b32 v52, 0
    v_mov_b32 v53, 0
    v_mov_b32 v54, 0
    v_mov_b32 v55, 0
    s_and_b32 s54, s16, 1
    s_lshr_b32 s55, s16, 1
    s_waitcnt vmcnt(11)
    v_lshlrev_b32 v128, 16, v96
    v_and_b32 v129, 0xffff0000, v96
    v_lshlrev_b32 v130, 16, v97
    v_and_b32 v131, 0xffff0000, v97
    v_lshlrev_b32 v132, 16, v98
    v_and_b32 v133, 0xffff0000, v98
    v_lshlrev_b32 v134, 16, v99
    v_and_b32 v135, 0xffff0000, v99
    v_lshlrev_b32 v136, 16, v100
    v_and_b32 v137, 0xffff0000, v100
    v_lshlrev_b32 v138, 16, v101
    v_and_b32 v139, 0xffff0000, v101
    v_lshlrev_b32 v140, 16, v102
    v_and_b32 v141, 0xffff0000, v102
    v_lshlrev_b32 v142, 16, v103
    v_and_b32 v143, 0xffff0000, v103
    v_lshlrev_b32 v144, 16, v104
    v_and_b32 v145, 0xffff0000, v104
    v_lshlrev_b32 v146, 16, v105
    v_and_b32 v147, 0xffff0000, v105
    v_lshlrev_b32 v148, 16, v106
    v_and_b32 v149, 0xffff0000, v106
    v_lshlrev_b32 v150, 16, v107
    v_and_b32 v151, 0xffff0000, v107
    v_lshlrev_b32 v152, 16, v108
    v_and_b32 v153, 0xffff0000, v108
    v_lshlrev_b32 v154, 16, v109
    v_and_b32 v155, 0xffff0000, v109
    v_lshlrev_b32 v156, 16, v110
    v_and_b32 v157, 0xffff0000, v110
    v_lshlrev_b32 v158, 16, v111
    v_and_b32 v159, 0xffff0000, v111
    v_lshlrev_b32 v160, 16, v112
    v_and_b32 v161, 0xffff0000, v112
    v_lshlrev_b32 v162, 16, v113
    v_and_b32 v163, 0xffff0000, v113
    v_lshlrev_b32 v164, 16, v114
    v_and_b32 v165, 0xffff0000, v114
    v_lshlrev_b32 v166, 16, v115
    v_and_b32 v167, 0xffff0000, v115
    v_lshlrev_b32 v168, 16, v116
    v_and_b32 v169, 0xffff0000, v116
    v_lshlrev_b32 v170, 16, v117
    v_and_b32 v171, 0xffff0000, v117
    v_lshlrev_b32 v172, 16, v118
    v_and_b32 v173, 0xffff0000, v118
    v_lshlrev_b32 v174, 16, v119
    v_and_b32 v175, 0xffff0000, v119
    v_lshlrev_b32 v176, 16, v120
    v_and_b32 v177, 0xffff0000, v120
    v_lshlrev_b32 v178, 16, v121
    v_and_b32 v179, 0xffff0000, v121
    v_lshlrev_b32 v180, 16, v122
    v_and_b32 v181, 0xffff0000, v122
    v_lshlrev_b32 v182, 16, v123
    v_and_b32 v183, 0xffff0000, v123
    v_lshlrev_b32 v184, 16, v124
    v_and_b32 v185, 0xffff0000, v124
    v_lshlrev_b32 v186, 16, v125
    v_and_b32 v187, 0xffff0000, v125
    v_lshlrev_b32 v188, 16, v126
    v_and_b32 v189, 0xffff0000, v126
    v_lshlrev_b32 v190, 16, v127
    v_and_b32 v191, 0xffff0000, v127
    v_pk_add_f32 v[56:57], v[128:129], v[136:137]
    v_pk_add_f32 v[58:59], v[130:131], v[138:139]
    v_pk_add_f32 v[60:61], v[132:133], v[140:141]
    v_pk_add_f32 v[62:63], v[134:135], v[142:143]
    v_pk_add_f32 v[56:57], v[56:57], v[144:145]
    v_pk_add_f32 v[58:59], v[58:59], v[146:147]
    v_pk_add_f32 v[60:61], v[60:61], v[148:149]
    v_pk_add_f32 v[62:63], v[62:63], v[150:151]
    v_pk_add_f32 v[56:57], v[56:57], v[152:153]
    v_pk_add_f32 v[58:59], v[58:59], v[154:155]
    v_pk_add_f32 v[60:61], v[60:61], v[156:157]
    v_pk_add_f32 v[62:63], v[62:63], v[158:159]
    v_pk_add_f32 v[56:57], v[56:57], v[160:161]
    v_pk_add_f32 v[58:59], v[58:59], v[162:163]
    v_pk_add_f32 v[60:61], v[60:61], v[164:165]
    v_pk_add_f32 v[62:63], v[62:63], v[166:167]
    v_pk_add_f32 v[56:57], v[56:57], v[168:169]
    v_pk_add_f32 v[58:59], v[58:59], v[170:171]
    v_pk_add_f32 v[60:61], v[60:61], v[172:173]
    v_pk_add_f32 v[62:63], v[62:63], v[174:175]
    v_pk_add_f32 v[56:57], v[56:57], v[176:177]
    v_pk_add_f32 v[58:59], v[58:59], v[178:179]
    v_pk_add_f32 v[60:61], v[60:61], v[180:181]
    v_pk_add_f32 v[62:63], v[62:63], v[182:183]
    v_pk_add_f32 v[56:57], v[56:57], v[184:185]
    v_pk_add_f32 v[58:59], v[58:59], v[186:187]
    v_pk_add_f32 v[60:61], v[60:61], v[188:189]
    v_pk_add_f32 v[62:63], v[62:63], v[190:191]
    v_pk_add_f32 v[56:57], v[56:57], v[58:59]
    v_pk_add_f32 v[60:61], v[60:61], v[62:63]
    v_pk_add_f32 v[56:57], v[56:57], v[60:61]
    v_add_f32 v64, v56, v57
    s_nop 1
    v_add_f32_dpp v64, v64, v64 quad_perm:[1,0,3,2] row_mask:0xf bank_mask:0xf
    s_nop 1
    v_add_f32_dpp v64, v64, v64 quad_perm:[2,3,0,1] row_mask:0xf bank_mask:0xf
    s_nop 1
    v_add_f32_dpp v64, v64, v64 row_half_mirror row_mask:0xf bank_mask:0xf
    s_mov_b32 s42, 0xbb000000
    v_mul_f32 v64, s42, v64
    v_pk_add_f32 v[128:129], v[128:129], v[64:65] op_sel_hi:[1,0]
    v_pk_add_f32 v[130:131], v[130:131], v[64:65] op_sel_hi:[1,0]
    v_pk_add_f32 v[132:133], v[132:133], v[64:65] op_sel_hi:[1,0]
    v_pk_add_f32 v[134:135], v[134:135], v[64:65] op_sel_hi:[1,0]
    v_pk_add_f32 v[136:137], v[136:137], v[64:65] op_sel_hi:[1,0]
    v_pk_add_f32 v[138:139], v[138:139], v[64:65] op_sel_hi:[1,0]
    v_pk_add_f32 v[140:141], v[140:141], v[64:65] op_sel_hi:[1,0]
    v_pk_add_f32 v[142:143], v[142:143], v[64:65] op_sel_hi:[1,0]
    v_pk_add_f32 v[144:145], v[144:145], v[64:65] op_sel_hi:[1,0]
    v_pk_add_f32 v[146:147], v[146:147], v[64:65] op_sel_hi:[1,0]
    v_pk_add_f32 v[148:149], v[148:149], v[64:65] op_sel_hi:[1,0]
    v_pk_add_f32 v[150:151], v[150:151], v[64:65] op_sel_hi:[1,0]
    v_pk_add_f32 v[152:153], v[152:153], v[64:65] op_sel_hi:[1,0]
    v_pk_add_f32 v[154:155], v[154:155], v[64:65] op_sel_hi:[1,0]
    v_pk_add_f32 v[156:157], v[156:157], v[64:65] op_sel_hi:[1,0]
    v_pk_add_f32 v[158:159], v[158:159], v[64:65] op_sel_hi:[1,0]
    v_pk_add_f32 v[160:161], v[160:161], v[64:65] op_sel_hi:[1,0]
    v_pk_add_f32 v[162:163], v[162:163], v[64:65] op_sel_hi:[1,0]
    v_pk_add_f32 v[164:165], v[164:165], v[64:65] op_sel_hi:[1,0]
    v_pk_add_f32 v[166:167], v[166:167], v[64:65] op_sel_hi:[1,0]
    v_pk_add_f32 v[168:169], v[168:169], v[64:65] op_sel_hi:[1,0]
    v_pk_add_f32 v[170:171], v[170:171], v[64:65] op_sel_hi:[1,0]
    v_pk_add_f32 v[172:173], v[172:173], v[64:65] op_sel_hi:[1,0]
    v_pk_add_f32 v[174:175], v[174:175], v[64:65] op_sel_hi:[1,0]
    v_pk_add_f32 v[176:177], v[176:177], v[64:65] op_sel_hi:[1,0]
    v_pk_add_f32 v[178:179], v[178:179], v[64:65] op_sel_hi:[1,0]
    v_pk_add_f32 v[180:181], v[180:181], v[64:65] op_sel_hi:[1,0]
    v_pk_add_f32 v[182:183], v[182:183], v[64:65] op_sel_hi:[1,0]
    v_pk_add_f32 v[184:185], v[184:185], v[64:65] op_sel_hi:[1,0]
    v_pk_add_f32 v[186:187], v[186:187], v[64:65] op_sel_hi:[1,0]
    v_pk_add_f32 v[188:189], v[188:189], v[64:65] op_sel_hi:[1,0]
    v_pk_add_f32 v[190:191], v[190:191], v[64:65] op_sel_hi:[1,0]
    v_pk_mul_f32 v[56:57], v[128:129], v[128:129]
    v_pk_mul_f32 v[58:59], v[130:131], v[130:131]
    v_pk_mul_f32 v[60:61], v[132:133], v[132:133]
    v_pk_mul_f32 v[62:63], v[134:135], v[134:135]
    v_pk_fma_f32 v[56:57], v[136:137], v[136:137], v[56:57]
    v_pk_fma_f32 v[58:59], v[138:139], v[138:139], v[58:59]
    v_pk_fma_f32 v[60:61], v[140:141], v[140:141], v[60:61]
    v_pk_fma_f32 v[62:63], v[142:143], v[142:143], v[62:63]
    v_pk_fma_f32 v[56:57], v[144:145], v[144:145], v[56:57]
    v_pk_fma_f32 v[58:59], v[146:147], v[146:147], v[58:59]
    v_pk_fma_f32 v[60:61], v[148:149], v[148:149], v[60:61]
    v_pk_fma_f32 v[62:63], v[150:151], v[150:151], v[62:63]
    v_pk_fma_f32 v[56:57], v[152:153], v[152:153], v[56:57]
    v_pk_fma_f32 v[58:59], v[154:155], v[154:155], v[58:59]
    v_pk_fma_f32 v[60:61], v[156:157], v[156:157], v[60:61]
    v_pk_fma_f32 v[62:63], v[158:159], v[158:159], v[62:63]
    v_pk_fma_f32 v[56:57], v[160:161], v[160:161], v[56:57]
    v_pk_fma_f32 v[58:59], v[162:163], v[162:163], v[58:59]
    v_pk_fma_f32 v[60:61], v[164:165], v[164:165], v[60:61]
    v_pk_fma_f32 v[62:63], v[166:167], v[166:167], v[62:63]
    v_pk_fma_f32 v[56:57], v[168:169], v[168:169], v[56:57]
    v_pk_fma_f32 v[58:59], v[170:171], v[170:171], v[58:59]
    v_pk_fma_f32 v[60:61], v[172:173], v[172:173], v[60:61]
    v_pk_fma_f32 v[62:63], v[174:175], v[174:175], v[62:63]
    v_pk_fma_f32 v[56:57], v[176:177], v[176:177], v[56:57]
    v_pk_fma_f32 v[58:59], v[178:179], v[178:179], v[58:59]
    v_pk_fma_f32 v[60:61], v[180:181], v[180:181], v[60:61]
    v_pk_fma_f32 v[62:63], v[182:183], v[182:183], v[62:63]
    v_pk_fma_f32 v[56:57], v[184:185], v[184:185], v[56:57]
    v_pk_fma_f32 v[58:59], v[186:187], v[186:187], v[58:59]
    v_pk_fma_f32 v[60:61], v[188:189], v[188:189], v[60:61]
    v_pk_fma_f32 v[62:63], v[190:191], v[190:191], v[62:63]
    v_pk_add_f32 v[56:57], v[56:57], v[58:59]
    v_pk_add_f32 v[60:61], v[60:61], v[62:63]
    v_pk_add_f32 v[56:57], v[56:57], v[60:61]
    v_add_f32 v66, v56, v57
    s_nop 1
    v_add_f32_dpp v66, v66, v66 quad_perm:[1,0,3,2] row_mask:0xf bank_mask:0xf
    s_nop 1
    v_add_f32_dpp v66, v66, v66 quad_perm:[2,3,0,1] row_mask:0xf bank_mask:0xf
    s_nop 1
    v_add_f32_dpp v66, v66, v66 row_half_mirror row_mask:0xf bank_mask:0xf
    s_mov_b32 s42, 0x3b000000
    v_mov_b32 v67, 0x3727c5ac
    v_fma_f32 v66, v66, s42, v67
    v_rsq_f32 v66, v66
    s_nop 0
    v_pk_mul_f32 v[128:129], v[128:129], v[66:67] op_sel_hi:[1,0]
    v_cvt_pk_bf16_f32 v96, v128, v129
    v_pk_mul_f32 v[130:131], v[130:131], v[66:67] op_sel_hi:[1,0]
    v_cvt_pk_bf16_f32 v97, v130, v131
    v_pk_mul_f32 v[132:133], v[132:133], v[66:67] op_sel_hi:[1,0]
    v_cvt_pk_bf16_f32 v98, v132, v133
    v_pk_mul_f32 v[134:135], v[134:135], v[66:67] op_sel_hi:[1,0]
    v_cvt_pk_bf16_f32 v99, v134, v135
    ds_write_b128 v7, v[96:99] offset:0
    v_pk_mul_f32 v[136:137], v[136:137], v[66:67] op_sel_hi:[1,0]
    v_cvt_pk_bf16_f32 v100, v136, v137
    v_pk_mul_f32 v[138:139], v[138:139], v[66:67] op_sel_hi:[1,0]
    v_cvt_pk_bf16_f32 v101, v138, v139
    v_pk_mul_f32 v[140:141], v[140:141], v[66:67] op_sel_hi:[1,0]
    v_cvt_pk_bf16_f32 v102, v140, v141
    v_pk_mul_f32 v[142:143], v[142:143], v[66:67] op_sel_hi:[1,0]
    v_cvt_pk_bf16_f32 v103, v142, v143
    ds_write_b128 v7, v[100:103] offset:8192
    v_pk_mul_f32 v[144:145], v[144:145], v[66:67] op_sel_hi:[1,0]
    v_cvt_pk_bf16_f32 v104, v144, v145
    v_pk_mul_f32 v[146:147], v[146:147], v[66:67] op_sel_hi:[1,0]
    v_cvt_pk_bf16_f32 v105, v146, v147
    v_pk_mul_f32 v[148:149], v[148:149], v[66:67] op_sel_hi:[1,0]
    v_cvt_pk_bf16_f32 v106, v148, v149
    v_pk_mul_f32 v[150:151], v[150:151], v[66:67] op_sel_hi:[1,0]
    v_cvt_pk_bf16_f32 v107, v150, v151
    ds_write_b128 v7, v[104:107] offset:16384
    v_pk_mul_f32 v[152:153], v[152:153], v[66:67] op_sel_hi:[1,0]
    v_cvt_pk_bf16_f32 v108, v152, v153
    v_pk_mul_f32 v[154:155], v[154:155], v[66:67] op_sel_hi:[1,0]
    v_cvt_pk_bf16_f32 v109, v154, v155
    v_pk_mul_f32 v[156:157], v[156:157], v[66:67] op_sel_hi:[1,0]
    v_cvt_pk_bf16_f32 v110, v156, v157
    v_pk_mul_f32 v[158:159], v[158:159], v[66:67] op_sel_hi:[1,0]
    v_cvt_pk_bf16_f32 v111, v158, v159
    ds_write_b128 v7, v[108:111] offset:24576
    v_pk_mul_f32 v[160:161], v[160:161], v[66:67] op_sel_hi:[1,0]
    v_cvt_pk_bf16_f32 v112, v160, v161
    v_pk_mul_f32 v[162:163], v[162:163], v[66:67] op_sel_hi:[1,0]
    v_cvt_pk_bf16_f32 v113, v162, v163
    v_pk_mul_f32 v[164:165], v[164:165], v[66:67] op_sel_hi:[1,0]
    v_cvt_pk_bf16_f32 v114, v164, v165
    v_pk_mul_f32 v[166:167], v[166:167], v[66:67] op_sel_hi:[1,0]
    v_cvt_pk_bf16_f32 v115, v166, v167
    ds_write_b128 v7, v[112:115] offset:32768
    v_pk_mul_f32 v[168:169], v[168:169], v[66:67] op_sel_hi:[1,0]
    v_cvt_pk_bf16_f32 v116, v168, v169
    v_pk_mul_f32 v[170:171], v[170:171], v[66:67] op_sel_hi:[1,0]
    v_cvt_pk_bf16_f32 v117, v170, v171
    v_pk_mul_f32 v[172:173], v[172:173], v[66:67] op_sel_hi:[1,0]
    v_cvt_pk_bf16_f32 v118, v172, v173
    v_pk_mul_f32 v[174:175], v[174:175], v[66:67] op_sel_hi:[1,0]
    v_cvt_pk_bf16_f32 v119, v174, v175
    ds_write_b128 v7, v[116:119] offset:40960
    v_pk_mul_f32 v[176:177], v[176:177], v[66:67] op_sel_hi:[1,0]
    v_cvt_pk_bf16_f32 v120, v176, v177
    v_pk_mul_f32 v[178:179], v[178:179], v[66:67] op_sel_hi:[1,0]
    v_cvt_pk_bf16_f32 v121, v178, v179
    v_pk_mul_f32 v[180:181], v[180:181], v[66:67] op_sel_hi:[1,0]
    v_cvt_pk_bf16_f32 v122, v180, v181
    v_pk_mul_f32 v[182:183], v[182:183], v[66:67] op_sel_hi:[1,0]
    v_cvt_pk_bf16_f32 v123, v182, v183
    ds_write_b128 v7, v[120:123] offset:49152
    v_pk_mul_f32 v[184:185], v[184:185], v[66:67] op_sel_hi:[1,0]
    v_cvt_pk_bf16_f32 v124, v184, v185
    v_pk_mul_f32 v[186:187], v[186:187], v[66:67] op_sel_hi:[1,0]
    v_cvt_pk_bf16_f32 v125, v186, v187
    v_pk_mul_f32 v[188:189], v[188:189], v[66:67] op_sel_hi:[1,0]
    v_cvt_pk_bf16_f32 v126, v188, v189
    v_pk_mul_f32 v[190:191], v[190:191], v[66:67] op_sel_hi:[1,0]
    v_cvt_pk_bf16_f32 v127, v190, v191
    ds_write_b128 v7, v[124:127] offset:57344
    s_add_u32 s47, s18, 1
    s_and_b32 s47, s47, 7
    s_mul_i32 s49, s47, 196608
    s_add_u32 s49, s49, s45
    s_add_u32 m0, s46, 80896
    s_nop 0
    buffer_load_dwordx4 v6, s[24:27], s49 offen offset:1024 lds
    s_add_u32 s47, s18, 1
    s_and_b32 s47, s47, 7
    s_mul_i32 s49, s47, 196608
    s_add_u32 s49, s49, s45
    s_add_u32 m0, s46, 88064
    s_nop 0
    buffer_load_dwordx4 v6, s[24:27], s49 offen offset:2048 lds
    s_add_u32 s47, s18, 2
    s_and_b32 s47, s47, 7
    s_mul_i32 s49, s47, 196608
    s_add_u32 s49, s49, s45
    s_add_u32 m0, s46, 97280
    s_nop 0
    buffer_load_dwordx4 v6, s[24:27], s49 offen offset:1024 lds
    s_add_u32 s47, s18, 2
    s_and_b32 s47, s47, 7
    s_mul_i32 s49, s47, 196608
    s_add_u32 s49, s49, s45
    s_add_u32 m0, s46, 104448
    s_nop 0
    buffer_load_dwordx4 v6, s[24:27], s49 offen offset:2048 lds
    s_add_u32 s47, s18, 3
    s_and_b32 s47, s47, 7
    s_mul_i32 s49, s47, 196608
    s_add_u32 s49, s49, s45
    s_add_u32 m0, s46, 113664
    s_nop 0
    buffer_load_dwordx4 v6, s[24:27], s49 offen offset:1024 lds
    s_add_u32 s47, s18, 3
    s_and_b32 s47, s47, 7
    s_mul_i32 s49, s47, 196608
    s_add_u32 s49, s49, s45
    s_add_u32 m0, s46, 120832
    s_nop 0
    buffer_load_dwordx4 v6, s[24:27], s49 offen offset:2048 lds
    s_add_u32 s47, s18, 4
    s_and_b32 s47, s47, 7
    s_mul_i32 s49, s47, 196608
    s_add_u32 s49, s49, s45
    s_add_u32 m0, s46, 130048
    s_nop 0
    buffer_load_dwordx4 v6, s[24:27], s49 offen offset:1024 lds
    s_add_u32 s47, s18, 4
    s_and_b32 s47, s47, 7
    s_mul_i32 s49, s47, 196608
    s_add_u32 s49, s49, s45
    s_add_u32 m0, s46, 137216
    s_nop 0
    buffer_load_dwordx4 v6, s[24:27], s49 offen offset:2048 lds
    v_mov_b32 v24, -1
    v_mov_b32 v25, -1
    v_mov_b32 v26, -1
    v_mov_b32 v27, -1
    v_lshlrev_b32 v23, 4, v1
    s_and_b32 s40, s2, 7
    s_lshl_b32 s41, s40, 2
    s_and_b32 s42, s17, 3
    s_add_u32 s41, s41, s42
    s_lshl_b32 s41, s41, 2
    s_and_b32 s42, s12, 3
    s_add_u32 s41, s41, s42
    s_lshr_b32 s42, s17, 2
    s_lshl_b32 s42, s42, 1
    s_lshr_b32 s43, s12, 2
    s_add_u32 s42, s42, s43
    s_lshl_b32 s66, s41, 4
    s_add_u32 s66, s66, s42
    s_lshl_b32 s66, s66, 10
    s_add_u32 s66, s66, 2162688
    buffer_store_dwordx4 v[24:27], v23, s[28:31], s66 offen sc1
    s_lshl_b32 s66, s41, 11
    s_bfe_u32 s67, s42, 0x10001
    s_lshl_b32 s67, s67, 10
    s_add_u32 s66, s66, s67
    s_lshr_b32 s67, s42, 2
    s_lshl_b32 s67, s67, 8
    s_add_u32 s66, s66, s67
    s_and_b32 s67, s42, 1
    s_lshl_b32 s67, s67, 3
    s_add_u32 s66, s66, s67
    s_add_u32 s66, s66, 9895936
    s_mov_b64 exec, 0xffff
    buffer_store_dwordx2 v[24:25], v23, s[28:31], s66 offen sc1
    s_mov_b64 exec, -1
    s_lshl_b32 s41, s40, 1
    s_and_b32 s42, s17, 1
    s_add_u32 s41, s41, s42
    s_lshl_b32 s41, s41, 3
    s_and_b32 s42, s12, 3
    s_lshl_b32 s42, s42, 1
    s_add_u32 s41, s41, s42
    s_add_u32 s41, s41, s43
    s_mul_i32 s41, s41, 43
    s_lshr_b32 s42, s17, 1
    s_mul_i32 s42, s42, 349528
    s_lshr_b32 s42, s42, 17
    s_add_u32 s41, s41, s42
    s_lshl_b32 s41, s41, 10
    s_add_u32 s41, s41, 4259840
    buffer_store_dwordx4 v[24:27], v23, s[28:31], s41 offen offset:0 sc1
    buffer_store_dwordx4 v[24:27], v23, s[28:31], s41 offen offset:1024 sc1
    buffer_store_dwordx4 v[24:27], v23, s[28:31], s41 offen offset:2048 sc1
    s_waitcnt vmcnt(11)
    s_waitcnt lgkmcnt(0)
    s_barrier
    ds_read_b128 v[56:59], v8 offset:0
    ds_read_b64_tr_b16 v[76:77], v10 offset:0
    ds_read_b64_tr_b16 v[78:79], v10 offset:512
    ds_read_b128 v[60:63], v8 offset:2048
    ds_read_b64_tr_b16 v[80:81], v10 offset:8192
    ds_read_b64_tr_b16 v[82:83], v10 offset:8704
    s_waitcnt lgkmcnt(3)
    v_mfma_f32_16x16x32_bf16 v[40:43], v[56:59], v[76:79], v[40:43]
    ds_read_b128 v[64:67], v9 offset:0
    s_waitcnt lgkmcnt(3)
    v_mfma_f32_16x16x32_bf16 v[44:47], v[60:63], v[76:79], v[44:47]
    ds_read_b64_tr_b16 v[88:89], v10 offset:4096
    ds_read_b64_tr_b16 v[90:91], v10 offset:4608
    s_waitcnt lgkmcnt(3)
    v_mfma_f32_16x16x32_bf16 v[48:51], v[56:59], v[80:83], v[48:51]
    ds_read_b128 v[68:71], v9 offset:2048
    v_mfma_f32_16x16x32_bf16 v[52:55], v[60:63], v[80:83], v[52:55]
    ds_read_b64_tr_b16 v[92:93], v10 offset:12288
    ds_read_b64_tr_b16 v[94:95], v10 offset:12800
    s_waitcnt lgkmcnt(3)
    v_mfma_f32_16x16x32_bf16 v[40:43], v[64:67], v[88:91], v[40:43]
    ds_read_b128 v[56:59], v8 offset:8192
    s_waitcnt lgkmcnt(3)
    v_mfma_f32_16x16x32_bf16 v[44:47], v[68:71], v[88:91], v[44:47]
    ds_read_b64_tr_b16 v[76:77], v10 offset:16384
    ds_read_b64_tr_b16 v[78:79], v10 offset:16896
    s_waitcnt lgkmcnt(3)
    v_mfma_f32_16x16x32_bf16 v[48:51], v[64:67], v[92:95], v[48:51]
    ds_read_b128 v[60:63], v8 offset:10240
    v_mfma_f32_16x16x32_bf16 v[52:55], v[68:71], v[92:95], v[52:55]
    ds_read_b64_tr_b16 v[80:81], v10 offset:24576
    ds_read_b64_tr_b16 v[82:83], v10 offset:25088
    s_waitcnt vmcnt(9)
    s_barrier
    s_waitcnt lgkmcnt(3)
    v_mfma_f32_16x16x32_bf16 v[40:43], v[56:59], v[76:79], v[40:43]
    ds_read_b128 v[64:67], v9 offset:8192
    s_waitcnt lgkmcnt(3)
    v_mfma_f32_16x16x32_bf16 v[44:47], v[60:63], v[76:79], v[44:47]
    ds_read_b64_tr_b16 v[88:89], v10 offset:20480
    ds_read_b64_tr_b16 v[90:91], v10 offset:20992
    s_add_u32 s47, s18, 5
    s_and_b32 s47, s47, 7
    s_mul_i32 s49, s47, 196608
    s_add_u32 s49, s49, s45
    s_add_u32 m0, s46, 64512
    s_nop 0
    buffer_load_dwordx4 v6, s[24:27], s49 offen offset:1024 lds
    s_waitcnt lgkmcnt(3)
    v_mfma_f32_16x16x32_bf16 v[48:51], v[56:59], v[80:83], v[48:51]
    ds_read_b128 v[68:71], v9 offset:10240
    v_mfma_f32_16x16x32_bf16 v[52:55], v[60:63], v[80:83], v[52:55]
    ds_read_b64_tr_b16 v[92:93], v10 offset:28672
    ds_read_b64_tr_b16 v[94:95], v10 offset:29184
    s_add_u32 s47, s18, 5
    s_and_b32 s47, s47, 7
    s_mul_i32 s49, s47, 196608
    s_add_u32 s49, s49, s45
    s_add_u32 m0, s46, 71680
    s_nop 0
    buffer_load_dwordx4 v6, s[24:27], s49 offen offset:2048 lds
    s_waitcnt lgkmcnt(3)
    v_mfma_f32_16x16x32_bf16 v[40:43], v[64:67], v[88:91], v[40:43]
    ds_read_b128 v[56:59], v8 offset:16384
    s_waitcnt lgkmcnt(3)
    v_mfma_f32_16x16x32_bf16 v[44:47], v[68:71], v[88:91], v[44:47]
    ds_read_b64_tr_b16 v[76:77], v10 offset:32768
    ds_read_b64_tr_b16 v[78:79], v10 offset:33280
    s_waitcnt lgkmcnt(3)
    v_mfma_f32_16x16x32_bf16 v[48:51], v[64:67], v[92:95], v[48:51]
    ds_read_b128 v[60:63], v8 offset:18432
    v_mfma_f32_16x16x32_bf16 v[52:55], v[68:71], v[92:95], v[52:55]
    ds_read_b64_tr_b16 v[80:81], v10 offset:40960
    ds_read_b64_tr_b16 v[82:83], v10 offset:41472
    s_waitcnt vmcnt(9)
    s_barrier
    v_mov_b32 v21, 1
    s_mov_b64 exec, 1
    buffer_atomic_add v21, v22, s[36:39], 0 offen offset:64
    s_mov_b64 exec, -1
    s_waitcnt lgkmcnt(3)
    v_mfma_f32_16x16x32_bf16 v[40:43], v[56:59], v[76:79], v[40:43]
    ds_read_b128 v[64:67], v9 offset:16384
    s_waitcnt lgkmcnt(3)
    v_mfma_f32_16x16x32_bf16 v[44:47], v[60:63], v[76:79], v[44:47]
    ds_read_b64_tr_b16 v[88:89], v10 offset:36864
    ds_read_b64_tr_b16 v[90:91], v10 offset:37376
    s_add_u32 s47, s18, 6
    s_and_b32 s47, s47, 7
    s_mul_i32 s49, s47, 196608
    s_add_u32 s49, s49, s45
    s_add_u32 m0, s46, 80896
    s_nop 0
    buffer_load_dwordx4 v6, s[24:27], s49 offen offset:1024 lds
    s_waitcnt lgkmcnt(3)
    v_mfma_f32_16x16x32_bf16 v[48:51], v[56:59], v[80:83], v[48:51]
    ds_read_b128 v[68:71], v9 offset:18432
    v_mfma_f32_16x16x32_bf16 v[52:55], v[60:63], v[80:83], v[52:55]
    ds_read_b64_tr_b16 v[92:93], v10 offset:45056
    ds_read_b64_tr_b16 v[94:95], v10 offset:45568
    s_add_u32 s47, s18, 6
    s_and_b32 s47, s47, 7
    s_mul_i32 s49, s47, 196608
    s_add_u32 s49, s49, s45
    s_add_u32 m0, s46, 88064
    s_nop 0
    buffer_load_dwordx4 v6, s[24:27], s49 offen offset:2048 lds
    s_waitcnt lgkmcnt(3)
    v_mfma_f32_16x16x32_bf16 v[40:43], v[64:67], v[88:91], v[40:43]
    ds_read_b128 v[56:59], v8 offset:24576
    s_waitcnt lgkmcnt(3)
    v_mfma_f32_16x16x32_bf16 v[44:47], v[68:71], v[88:91], v[44:47]
    ds_read_b64_tr_b16 v[76:77], v11 offset:0
    ds_read_b64_tr_b16 v[78:79], v11 offset:512
    s_waitcnt lgkmcnt(3)
    v_mfma_f32_16x16x32_bf16 v[48:51], v[64:67], v[92:95], v[48:51]
    ds_read_b128 v[60:63], v8 offset:26624
    v_mfma_f32_16x16x32_bf16 v[52:55], v[68:71], v[92:95], v[52:55]
    ds_read_b64_tr_b16 v[80:81], v11 offset:8192
    ds_read_b64_tr_b16 v[82:83], v11 offset:8704
    s_waitcnt vmcnt(10)
    s_barrier
    s_waitcnt lgkmcnt(3)
    v_mfma_f32_16x16x32_bf16 v[40:43], v[56:59], v[76:79], v[40:43]
    ds_read_b128 v[64:67], v9 offset:24576
    s_waitcnt lgkmcnt(3)
    v_mfma_f32_16x16x32_bf16 v[44:47], v[60:63], v[76:79], v[44:47]
    ds_read_b64_tr_b16 v[88:89], v11 offset:4096
    ds_read_b64_tr_b16 v[90:91], v11 offset:4608
    s_add_u32 s47, s18, 7
    s_and_b32 s47, s47, 7
    s_mul_i32 s49, s47, 196608
    s_add_u32 s49, s49, s45
    s_add_u32 m0, s46, 97280
    s_nop 0
    buffer_load_dwordx4 v6, s[24:27], s49 offen offset:1024 lds
    s_waitcnt lgkmcnt(3)
    v_mfma_f32_16x16x32_bf16 v[48:51], v[56:59], v[80:83], v[48:51]
    ds_read_b128 v[68:71], v9 offset:26624
    v_mfma_f32_16x16x32_bf16 v[52:55], v[60:63], v[80:83], v[52:55]
    ds_read_b64_tr_b16 v[92:93], v11 offset:12288
    ds_read_b64_tr_b16 v[94:95], v11 offset:12800
    s_add_u32 s47, s18, 7
    s_and_b32 s47, s47, 7
    s_mul_i32 s49, s47, 196608
    s_add_u32 s49, s49, s45
    s_add_u32 m0, s46, 104448
    s_nop 0
    buffer_load_dwordx4 v6, s[24:27], s49 offen offset:2048 lds
    s_waitcnt lgkmcnt(3)
    v_mfma_f32_16x16x32_bf16 v[40:43], v[64:67], v[88:91], v[40:43]
    ds_read_b128 v[56:59], v8 offset:32768
    s_waitcnt lgkmcnt(3)
    v_mfma_f32_16x16x32_bf16 v[44:47], v[68:71], v[88:91], v[44:47]
    ds_read_b64_tr_b16 v[76:77], v11 offset:16384
    ds_read_b64_tr_b16 v[78:79], v11 offset:16896
    s_waitcnt lgkmcnt(3)
    v_mfma_f32_16x16x32_bf16 v[48:51], v[64:67], v[92:95], v[48:51]
    ds_read_b128 v[60:63], v8 offset:34816
    v_mfma_f32_16x16x32_bf16 v[52:55], v[68:71], v[92:95], v[52:55]
    ds_read_b64_tr_b16 v[80:81], v11 offset:24576
    ds_read_b64_tr_b16 v[82:83], v11 offset:25088
    s_waitcnt vmcnt(5)
    s_barrier
    s_waitcnt lgkmcnt(3)
    v_mfma_f32_16x16x32_bf16 v[40:43], v[56:59], v[76:79], v[40:43]
    ds_read_b128 v[64:67], v9 offset:32768
    s_waitcnt lgkmcnt(3)
    v_mfma_f32_16x16x32_bf16 v[44:47], v[60:63], v[76:79], v[44:47]
    ds_read_b64_tr_b16 v[88:89], v11 offset:20480
    ds_read_b64_tr_b16 v[90:91], v11 offset:20992
    s_add_u32 s47, s18, 0
    s_and_b32 s47, s47, 7
    s_mul_i32 s49, s47, 196608
    s_add_u32 s49, s49, s45
    s_add_u32 m0, s46, 114688
    s_nop 0
    buffer_load_dwordx4 v6, s[24:27], s49 offen offset:0 lds
    s_waitcnt lgkmcnt(3)
    v_mfma_f32_16x16x32_bf16 v[48:51], v[56:59], v[80:83], v[48:51]
    ds_read_b128 v[68:71], v9 offset:34816
    v_mfma_f32_16x16x32_bf16 v[52:55], v[60:63], v[80:83], v[52:55]
    ds_read_b64_tr_b16 v[92:93], v11 offset:28672
    ds_read_b64_tr_b16 v[94:95], v11 offset:29184
    s_add_u32 s47, s18, 1
    s_and_b32 s47, s47, 7
    s_mul_i32 s49, s47, 196608
    s_add_u32 s49, s49, s45
    s_add_u32 m0, s46, 122880
    s_nop 0
    buffer_load_dwordx4 v6, s[24:27], s49 offen offset:0 lds
    s_waitcnt lgkmcnt(3)
    v_mfma_f32_16x16x32_bf16 v[40:43], v[64:67], v[88:91], v[40:43]
    ds_read_b128 v[56:59], v8 offset:40960
    s_waitcnt lgkmcnt(3)
    v_mfma_f32_16x16x32_bf16 v[44:47], v[68:71], v[88:91], v[44:47]
    ds_read_b64_tr_b16 v[76:77], v10 offset:0
    ds_read_b64_tr_b16 v[78:79], v10 offset:512
    s_waitcnt lgkmcnt(3)
    v_mfma_f32_16x16x32_bf16 v[48:51], v[64:67], v[92:95], v[48:51]
    ds_read_b128 v[60:63], v8 offset:43008
    v_mfma_f32_16x16x32_bf16 v[52:55], v[68:71], v[92:95], v[52:55]
    ds_read_b64_tr_b16 v[80:81], v10 offset:8192
    ds_read_b64_tr_b16 v[82:83], v10 offset:8704
    s_waitcnt vmcnt(4)
    s_barrier
    s_waitcnt lgkmcnt(3)
    v_mfma_f32_16x16x32_bf16 v[40:43], v[56:59], v[76:79], v[40:43]
    ds_read_b128 v[64:67], v9 offset:40960
    s_waitcnt lgkmcnt(3)
    v_mfma_f32_16x16x32_bf16 v[44:47], v[60:63], v[76:79], v[44:47]
    ds_read_b64_tr_b16 v[88:89], v10 offset:4096
    ds_read_b64_tr_b16 v[90:91], v10 offset:4608
    s_add_u32 s47, s18, 2
    s_and_b32 s47, s47, 7
    s_mul_i32 s49, s47, 196608
    s_add_u32 s49, s49, s45
    s_add_u32 m0, s46, 131072
    s_nop 0
    buffer_load_dwordx4 v6, s[24:27], s49 offen offset:0 lds
    s_waitcnt lgkmcnt(3)
    v_mfma_f32_16x16x32_bf16 v[48:51], v[56:59], v[80:83], v[48:51]
    ds_read_b128 v[68:71], v9 offset:43008
    v_mfma_f32_16x16x32_bf16 v[52:55], v[60:63], v[80:83], v[52:55]
    ds_read_b64_tr_b16 v[92:93], v10 offset:12288
    ds_read_b64_tr_b16 v[94:95], v10 offset:12800
    s_add_u32 s47, s18, 3
    s_and_b32 s47, s47, 7
    s_mul_i32 s49, s47, 196608
    s_add_u32 s49, s49, s45
    s_add_u32 m0, s46, 139264
    s_nop 0
    buffer_load_dwordx4 v6, s[24:27], s49 offen offset:0 lds
    s_waitcnt lgkmcnt(3)
    v_mfma_f32_16x16x32_bf16 v[40:43], v[64:67], v[88:91], v[40:43]
    ds_read_b128 v[56:59], v8 offset:49152
    s_waitcnt lgkmcnt(3)
    v_mfma_f32_16x16x32_bf16 v[44:47], v[68:71], v[88:91], v[44:47]
    ds_read_b64_tr_b16 v[76:77], v10 offset:16384
    ds_read_b64_tr_b16 v[78:79], v10 offset:16896
    s_waitcnt lgkmcnt(3)
    v_mfma_f32_16x16x32_bf16 v[48:51], v[64:67], v[92:95], v[48:51]
    ds_read_b128 v[60:63], v8 offset:51200
    v_mfma_f32_16x16x32_bf16 v[52:55], v[68:71], v[92:95], v[52:55]
    ds_read_b64_tr_b16 v[80:81], v10 offset:24576
    ds_read_b64_tr_b16 v[82:83], v10 offset:25088
    s_waitcnt vmcnt(4)
    s_barrier
    s_mov_b64 exec, 0x1ff
    buffer_load_dword v4, v15, s[32:35], 0 offen offset:64 sc1
    s_mov_b64 exec, -1
    s_waitcnt lgkmcnt(3)
    v_mfma_f32_16x16x32_bf16 v[40:43], v[56:59], v[76:79], v[40:43]
    ds_read_b128 v[64:67], v9 offset:49152
    s_waitcnt lgkmcnt(3)
    v_mfma_f32_16x16x32_bf16 v[44:47], v[60:63], v[76:79], v[44:47]
    ds_read_b64_tr_b16 v[88:89], v10 offset:20480
    ds_read_b64_tr_b16 v[90:91], v10 offset:20992
    s_add_u32 s47, s18, 4
    s_and_b32 s47, s47, 7
    s_mul_i32 s49, s47, 196608
    s_add_u32 s49, s49, s45
    s_add_u32 m0, s46, 65536
    s_nop 0
    buffer_load_dwordx4 v6, s[24:27], s49 offen offset:0 lds
    s_waitcnt lgkmcnt(3)
    v_mfma_f32_16x16x32_bf16 v[48:51], v[56:59], v[80:83], v[48:51]
    ds_read_b128 v[68:71], v9 offset:51200
    v_mfma_f32_16x16x32_bf16 v[52:55], v[60:63], v[80:83], v[52:55]
    ds_read_b64_tr_b16 v[92:93], v10 offset:28672
    ds_read_b64_tr_b16 v[94:95], v10 offset:29184
    s_add_u32 s47, s18, 5
    s_and_b32 s47, s47, 7
    s_mul_i32 s49, s47, 196608
    s_add_u32 s49, s49, s45
    s_add_u32 m0, s46, 73728
    s_nop 0
    buffer_load_dwordx4 v6, s[24:27], s49 offen offset:0 lds
    s_waitcnt lgkmcnt(3)
    v_mfma_f32_16x16x32_bf16 v[40:43], v[64:67], v[88:91], v[40:43]
    ds_read_b128 v[56:59], v8 offset:57344
    s_waitcnt lgkmcnt(3)
    v_mfma_f32_16x16x32_bf16 v[44:47], v[68:71], v[88:91], v[44:47]
    ds_read_b64_tr_b16 v[76:77], v10 offset:32768
    ds_read_b64_tr_b16 v[78:79], v10 offset:33280
    s_waitcnt lgkmcnt(3)
    v_mfma_f32_16x16x32_bf16 v[48:51], v[64:67], v[92:95], v[48:51]
    ds_read_b128 v[60:63], v8 offset:59392
    v_mfma_f32_16x16x32_bf16 v[52:55], v[68:71], v[92:95], v[52:55]
    ds_read_b64_tr_b16 v[80:81], v10 offset:40960
    ds_read_b64_tr_b16 v[82:83], v10 offset:41472
    s_waitcnt vmcnt(7)
    s_barrier
    s_waitcnt lgkmcnt(3)
    v_mfma_f32_16x16x32_bf16 v[40:43], v[56:59], v[76:79], v[40:43]
    ds_read_b128 v[64:67], v9 offset:57344
    s_waitcnt lgkmcnt(3)
    v_mfma_f32_16x16x32_bf16 v[44:47], v[60:63], v[76:79], v[44:47]
    ds_read_b64_tr_b16 v[88:89], v10 offset:36864
    ds_read_b64_tr_b16 v[90:91], v10 offset:37376
    s_add_u32 s47, s18, 6
    s_and_b32 s47, s47, 7
    s_mul_i32 s49, s47, 196608
    s_add_u32 s49, s49, s45
    s_add_u32 m0, s46, 81920
    s_nop 0
    buffer_load_dwordx4 v6, s[24:27], s49 offen offset:0 lds
    s_waitcnt lgkmcnt(3)
    v_mfma_f32_16x16x32_bf16 v[48:51], v[56:59], v[80:83], v[48:51]
    ds_read_b128 v[68:71], v9 offset:59392
    v_mfma_f32_16x16x32_bf16 v[52:55], v[60:63], v[80:83], v[52:55]
    ds_read_b64_tr_b16 v[92:93], v10 offset:45056
    ds_read_b64_tr_b16 v[94:95], v10 offset:45568
    s_add_u32 s47, s18, 7
    s_and_b32 s47, s47, 7
    s_mul_i32 s49, s47, 196608
    s_add_u32 s49, s49, s45
    s_add_u32 m0, s46, 90112
    s_nop 0
    buffer_load_dwordx4 v6, s[24:27], s49 offen offset:0 lds
    s_waitcnt lgkmcnt(3)
    v_mfma_f32_16x16x32_bf16 v[40:43], v[64:67], v[88:91], v[40:43]
    s_waitcnt lgkmcnt(2)
    v_mfma_f32_16x16x32_bf16 v[44:47], v[68:71], v[88:91], v[44:47]
    s_waitcnt lgkmcnt(0)
    v_mfma_f32_16x16x32_bf16 v[48:51], v[64:67], v[92:95], v[48:51]
    v_mfma_f32_16x16x32_bf16 v[52:55], v[68:71], v[92:95], v[52:55]
    s_mov_b32 s42, 0x3fb8aa3b
    s_mov_b32 s43, 0x3fb8aa3b
    s_mov_b32 s56, 0x358637bd
    s_mov_b32 s57, 0x358637bd
    s_mov_b32 s58, 1.0
    s_mov_b32 s59, 1.0
    v_pk_mul_f32 v[96:97], v[40:41], s[42:43]
    v_pk_mul_f32 v[98:99], v[42:43], s[42:43]
    v_pk_mul_f32 v[100:101], v[44:45], s[42:43]
    v_pk_mul_f32 v[102:103], v[46:47], s[42:43]
    v_exp_f32 v96, v96
    v_exp_f32 v97, v97
    v_exp_f32 v98, v98
    v_exp_f32 v99, v99
    v_exp_f32 v100, v100
    v_exp_f32 v101, v101
    v_exp_f32 v102, v102
    v_exp_f32 v103, v103
    v_pk_add_f32 v[104:105], v[40:41], s[58:59]
    v_pk_add_f32 v[106:107], v[42:43], s[58:59]
    v_pk_add_f32 v[108:109], v[44:45], s[58:59]
    v_pk_add_f32 v[110:111], v[46:47], s[58:59]
    v_cmp_lt_f32 s[60:61], 0, v40
    v_cmp_lt_f32 s[62:63], 0, v41
    s_nop 0
    v_cndmask_b32 v40, v96, v104, s[60:61]
    v_cndmask_b32 v41, v97, v105, s[62:63]
    v_cmp_lt_f32 s[60:61], 0, v42
    v_cmp_lt_f32 s[62:63], 0, v43
    s_nop 0
    v_cndmask_b32 v42, v98, v106, s[60:61]
    v_cndmask_b32 v43, v99, v107, s[62:63]
    v_cmp_lt_f32 s[60:61], 0, v44
    v_cmp_lt_f32 s[62:63], 0, v45
    s_nop 0
    v_cndmask_b32 v44, v100, v108, s[60:61]
    v_cndmask_b32 v45, v101, v109, s[62:63]
    v_cmp_lt_f32 s[60:61], 0, v46
    v_cmp_lt_f32 s[62:63], 0, v47
    s_nop 0
    v_cndmask_b32 v46, v102, v110, s[60:61]
    v_cndmask_b32 v47, v103, v111, s[62:63]
    v_pk_add_f32 v[40:41], v[40:41], s[56:57]
    v_pk_add_f32 v[42:43], v[42:43], s[56:57]
    v_pk_add_f32 v[44:45], v[44:45], s[56:57]
    v_pk_add_f32 v[46:47], v[46:47], s[56:57]
    v_cvt_pk_bf16_f32 v92, v40, v41
    v_cvt_pk_bf16_f32 v112, v48, v49
    v_cvt_pk_bf16_f32 v93, v42, v43
    v_cvt_pk_bf16_f32 v113, v50, v51
    v_cvt_pk_bf16_f32 v94, v44, v45
    v_cvt_pk_bf16_f32 v114, v52, v53
    v_cvt_pk_bf16_f32 v95, v46, v47
    v_cvt_pk_bf16_f32 v115, v54, v55
    s_nop 1
    v_mfma_f32_16x16x32_bf16 v[40:43], v[92:95], v[112:115], 0
    v_mfma_f32_16x16x32_bf16 v[44:47], v[92:95], v[16:19], 0
    v_lshlrev_b32 v12, 4, v1
    s_lshl_b32 s41, s16, 1
    s_add_u32 s41, s41, s15
    s_lshl_b32 s42, s41, 10
    s_add_u32 s42, s42, 147456
    v_add_u32 v13, s42, v12
    s_nop 0
    ds_write_b128 v13, v[40:43]
    s_lshl_b32 s42, s41, 6
    s_add_u32 s42, s42, 155648
    v_lshlrev_b32 v14, 4, v3
    v_add_u32 v14, s42, v14
    ds_write_b128 v14, v[44:47]
    s_waitcnt vmcnt(4)
    v_mov_b32 v116, 0
    v_cmp_eq_u32 vcc, 0, v2
    v_mov_b32 v124, 0x3f80
    s_nop 0
    v_cndmask_b32 v116, v116, v124, vcc
    v_cmp_eq_u32 vcc, 1, v2
    v_mov_b32 v124, 0x3f800000
    s_nop 0
    v_cndmask_b32 v116, v116, v124, vcc
    v_mov_b32 v117, 0
    v_cmp_eq_u32 vcc, 2, v2
    v_mov_b32 v124, 0x3f80
    s_nop 0
    v_cndmask_b32 v117, v117, v124, vcc
    v_cmp_eq_u32 vcc, 3, v2
    v_mov_b32 v124, 0x3f800000
    s_nop 0
    v_cndmask_b32 v117, v117, v124, vcc
    v_mov_b32 v118, 0
    v_cmp_eq_u32 vcc, 4, v2
    v_mov_b32 v124, 0x3f80
    s_nop 0
    v_cndmask_b32 v118, v118, v124, vcc
    v_cmp_eq_u32 vcc, 5, v2
    v_mov_b32 v124, 0x3f800000
    s_nop 0
    v_cndmask_b32 v118, v118, v124, vcc
    v_mov_b32 v119, 0
    v_cmp_eq_u32 vcc, 6, v2
    v_mov_b32 v124, 0x3f80
    s_nop 0
    v_cndmask_b32 v119, v119, v124, vcc
    v_cmp_eq_u32 vcc, 7, v2
    v_mov_b32 v124, 0x3f800000
    s_nop 0
    v_cndmask_b32 v119, v119, v124, vcc
    s_nop 1
    v_mfma_f32_16x16x32_bf16 v[120:123], v[116:119], v[192:195], 0
    s_nop 7
    v_add_f32_dpp v120, v120, v120 row_ror:4 row_mask:0xf bank_mask:0xf
    v_add_f32_dpp v121, v121, v121 row_ror:4 row_mask:0xf bank_mask:0xf
    v_add_f32_dpp v122, v122, v122 row_ror:4 row_mask:0xf bank_mask:0xf
    v_add_f32_dpp v123, v123, v123 row_ror:4 row_mask:0xf bank_mask:0xf
    v_add_f32_dpp v120, v120, v120 row_ror:8 row_mask:0xf bank_mask:0xf
    v_add_f32_dpp v121, v121, v121 row_ror:8 row_mask:0xf bank_mask:0xf
    v_add_f32_dpp v122, v122, v122 row_ror:8 row_mask:0xf bank_mask:0xf
    v_add_f32_dpp v123, v123, v123 row_ror:8 row_mask:0xf bank_mask:0xf
    v_and_b32 v124, 3, v2
    v_lshlrev_b32 v124, 5, v124
    v_and_b32 v125, 1, v3
    v_lshl_add_u32 v124, v125, 4, v124
    v_lshrrev_b32 v125, 1, v3
    v_lshl_add_u32 v124, v125, 10, v124
    s_lshl_b32 s42, s12, 7
    s_add_u32 s42, s42, 156672
    v_add_u32 v124, s42, v124
    ds_write_b128 v124, v[120:123]
    s_cmp_lg_u32 s12, 0
    s_nop 0
    s_cbranch_scc1 K1_NOPOLL
    s_mov_b64 exec, 0x1ff
    s_mov_b32 s43, 0
K1_POLL:
    v_cmp_eq_u32 vcc, 0, v4
    s_add_u32 s43, s43, 1
    s_nop 3
    s_cbranch_vccz K1_POLLX
    s_cmp_gt_u32 s43, 0x40000
    s_cbranch_scc1 K1_POLLX
    buffer_load_dword v4, v15, s[32:35], 0 offen offset:64 sc1
    s_waitcnt vmcnt(0)
    s_branch K1_POLL
K1_POLLX:
    s_mov_b64 exec, -1
K1_NOPOLL:
    s_waitcnt vmcnt(0)
    s_waitcnt lgkmcnt(0)
    s_barrier
    v_lshrrev_b32 v13, 8, v0
    v_and_b32 v14, 255, v0
    v_lshlrev_b32 v4, 2, v14
    v_lshl_add_u32 v4, v13, 11, v4
    v_add_u32 v4, 147456, v4
    ds_read_b32 v100, v4 offset:0
    ds_read_b32 v101, v4 offset:1024
    ds_read_b32 v102, v4 offset:4096
    ds_read_b32 v103, v4 offset:5120
    s_mul_i32 s41, s14, 4352
    v_mul_u32_u24 v13, 1088, v13
    v_lshl_add_u32 v13, v14, 2, v13
    s_waitcnt lgkmcnt(0)
    v_add_f32 v100, v100, v101
    v_add_f32 v102, v102, v103
    buffer_atomic_add_f32 v100, v13, s[28:31], s41 offen
    buffer_atomic_add_f32 v102, v13, s[28:31], s41 offen offset:2176
    s_cmp_gt_u32 s12, 1
    s_cbranch_scc1 K1_Q
    s_cmp_eq_u32 s12, 1
    s_cbranch_scc1 K1_CS2
    v_lshlrev_b32 v4, 2, v2
    v_lshl_add_u32 v4, v3, 7, v4
    v_add_u32 v4, 155648, v4
    ds_read_b32 v104, v4
    ds_read_b32 v105, v4 offset:64
    v_mul_u32_u24 v13, 1088, v3
    v_lshl_add_u32 v13, v2, 2, v13
    s_waitcnt lgkmcnt(0)
    v_add_f32 v104, v104, v105
    buffer_atomic_add_f32 v104, v13, s[28:31], s41 offen offset:1024
    s_nop 1
    s_branch K1_Q
K1_CS2:
    s_cmp_ge_u32 s2, 215
    s_cbranch_scc1 K1_Q
    s_mov_b32 exec_hi, 0
    v_lshlrev_b32 v124, 2, v1
    v_add_u32 v125, 156672, v124
    ds_read_b32 v112, v125 offset:0
    ds_read_b32 v113, v125 offset:128
    ds_read_b32 v114, v125 offset:256
    ds_read_b32 v115, v125 offset:384
    ds_read_b32 v116, v125 offset:512
    ds_read_b32 v117, v125 offset:640
    ds_read_b32 v118, v125 offset:768
    ds_read_b32 v119, v125 offset:896
    s_lshl_b32 s42, s53, 7
    s_add_u32 s42, s42, 36864
    s_waitcnt lgkmcnt(0)
    v_add_f32 v112, v112, v113
    v_add_f32 v112, v112, v114
    v_add_f32 v112, v112, v115
    v_add_f32 v112, v112, v116
    v_add_f32 v112, v112, v117
    v_add_f32 v112, v112, v118
    v_add_f32 v112, v112, v119
    buffer_atomic_add_f32 v112, v124, s[28:31], s42 offen
    s_mov_b64 exec, -1
    s_nop 0
K1_Q:
    ds_read_b128 v[56:59], v8 offset:0
    ds_read_b64_tr_b16 v[72:73], v11 offset:0
    ds_read_b64_tr_b16 v[74:75], v11 offset:512
    ds_read_b128 v[60:63], v8 offset:2048
    s_waitcnt lgkmcnt(1)
    v_mfma_f32_16x16x32_bf16 v[32:35], v[72:75], v[56:59], v[32:35]
    ds_read_b128 v[64:67], v9 offset:0
    ds_read_b64_tr_b16 v[84:85], v11 offset:4096
    ds_read_b64_tr_b16 v[86:87], v11 offset:4608
    s_waitcnt lgkmcnt(3)
    v_mfma_f32_16x16x32_bf16 v[36:39], v[72:75], v[60:63], v[36:39]
    ds_read_b128 v[68:71], v9 offset:2048
    s_waitcnt lgkmcnt(1)
    v_mfma_f32_16x16x32_bf16 v[32:35], v[84:87], v[64:67], v[32:35]
    ds_read_b128 v[56:59], v8 offset:8192
    ds_read_b64_tr_b16 v[72:73], v11 offset:8192
    ds_read_b64_tr_b16 v[74:75], v11 offset:8704
    s_waitcnt lgkmcnt(3)
    v_mfma_f32_16x16x32_bf16 v[36:39], v[84:87], v[68:71], v[36:39]
    ds_read_b128 v[60:63], v8 offset:10240
    s_waitcnt lgkmcnt(1)
    v_mfma_f32_16x16x32_bf16 v[32:35], v[72:75], v[56:59], v[32:35]
    ds_read_b128 v[64:67], v9 offset:8192
    ds_read_b64_tr_b16 v[84:85], v11 offset:12288
    ds_read_b64_tr_b16 v[86:87], v11 offset:12800
    s_waitcnt lgkmcnt(3)
    v_mfma_f32_16x16x32_bf16 v[36:39], v[72:75], v[60:63], v[36:39]
    ds_read_b128 v[68:71], v9 offset:10240
    s_waitcnt lgkmcnt(1)
    v_mfma_f32_16x16x32_bf16 v[32:35], v[84:87], v[64:67], v[32:35]
    ds_read_b128 v[56:59], v8 offset:16384
    ds_read_b64_tr_b16 v[72:73], v11 offset:16384
    ds_read_b64_tr_b16 v[74:75], v11 offset:16896
    s_waitcnt lgkmcnt(3)
    v_mfma_f32_16x16x32_bf16 v[36:39], v[84:87], v[68:71], v[36:39]
    ds_read_b128 v[60:63], v8 offset:18432
    s_waitcnt lgkmcnt(1)
    v_mfma_f32_16x16x32_bf16 v[32:35], v[72:75], v[56:59], v[32:35]
    ds_read_b128 v[64:67], v9 offset:16384
    ds_read_b64_tr_b16 v[84:85], v11 offset:20480
    ds_read_b64_tr_b16 v[86:87], v11 offset:20992
    s_waitcnt lgkmcnt(3)
    v_mfma_f32_16x16x32_bf16 v[36:39], v[72:75], v[60:63], v[36:39]
    ds_read_b128 v[68:71], v9 offset:18432
    s_waitcnt lgkmcnt(1)
    v_mfma_f32_16x16x32_bf16 v[32:35], v[84:87], v[64:67], v[32:35]
    ds_read_b128 v[56:59], v8 offset:24576
    ds_read_b64_tr_b16 v[72:73], v11 offset:24576
    ds_read_b64_tr_b16 v[74:75], v11 offset:25088
    s_waitcnt lgkmcnt(3)
    v_mfma_f32_16x16x32_bf16 v[36:39], v[84:87], v[68:71], v[36:39]
    ds_read_b128 v[60:63], v8 offset:26624
    s_waitcnt lgkmcnt(1)
    v_mfma_f32_16x16x32_bf16 v[32:35], v[72:75], v[56:59], v[32:35]
    ds_read_b128 v[64:67], v9 offset:24576
    ds_read_b64_tr_b16 v[84:85], v11 offset:28672
    ds_read_b64_tr_b16 v[86:87], v11 offset:29184
    s_waitcnt lgkmcnt(3)
    v_mfma_f32_16x16x32_bf16 v[36:39], v[72:75], v[60:63], v[36:39]
    ds_read_b128 v[68:71], v9 offset:26624
    s_waitcnt lgkmcnt(1)
    v_mfma_f32_16x16x32_bf16 v[32:35], v[84:87], v[64:67], v[32:35]
    ds_read_b128 v[56:59], v8 offset:32768
    ds_read_b64_tr_b16 v[72:73], v10 offset:0
    ds_read_b64_tr_b16 v[74:75], v10 offset:512
    s_waitcnt lgkmcnt(3)
    v_mfma_f32_16x16x32_bf16 v[36:39], v[84:87], v[68:71], v[36:39]
    ds_read_b128 v[60:63], v8 offset:34816
    s_waitcnt vmcnt(0)
    s_barrier
    s_cmp_lg_u32 s12, 0
    s_nop 3
    s_cbranch_scc1 K1_NS
    s_lshr_b32 s40, s2, 4
    s_lshl_b32 s40, s40, 8
    s_add_u32 s40, s40, 10158080
    v_mov_b32 v248, 0
    v_mov_b32 v249, 1
    s_mov_b64 exec, 1
    buffer_atomic_add v249, v248, s[28:31], s40 offen sc0
    s_mov_b64 exec, -1
K1_NS:
    s_waitcnt lgkmcnt(1)
    v_mfma_f32_16x16x32_bf16 v[32:35], v[72:75], v[56:59], v[32:35]
    ds_read_b128 v[64:67], v9 offset:32768
    ds_read_b64_tr_b16 v[84:85], v10 offset:4096
    ds_read_b64_tr_b16 v[86:87], v10 offset:4608
    s_waitcnt lgkmcnt(3)
    v_mfma_f32_16x16x32_bf16 v[36:39], v[72:75], v[60:63], v[36:39]
    ds_read_b128 v[68:71], v9 offset:34816
    s_waitcnt lgkmcnt(1)
    v_mfma_f32_16x16x32_bf16 v[32:35], v[84:87], v[64:67], v[32:35]
    ds_read_b128 v[56:59], v8 offset:40960
    ds_read_b64_tr_b16 v[72:73], v10 offset:8192
    ds_read_b64_tr_b16 v[74:75], v10 offset:8704
    s_waitcnt lgkmcnt(3)
    v_mfma_f32_16x16x32_bf16 v[36:39], v[84:87], v[68:71], v[36:39]
    ds_read_b128 v[60:63], v8 offset:43008
    s_waitcnt lgkmcnt(1)
    v_mfma_f32_16x16x32_bf16 v[32:35], v[72:75], v[56:59], v[32:35]
    ds_read_b128 v[64:67], v9 offset:40960
    ds_read_b64_tr_b16 v[84:85], v10 offset:12288
    ds_read_b64_tr_b16 v[86:87], v10 offset:12800
    s_waitcnt lgkmcnt(3)
    v_mfma_f32_16x16x32_bf16 v[36:39], v[72:75], v[60:63], v[36:39]
    ds_read_b128 v[68:71], v9 offset:43008
    s_waitcnt lgkmcnt(1)
    v_mfma_f32_16x16x32_bf16 v[32:35], v[84:87], v[64:67], v[32:35]
    ds_read_b128 v[56:59], v8 offset:49152
    ds_read_b64_tr_b16 v[72:73], v10 offset:16384
    ds_read_b64_tr_b16 v[74:75], v10 offset:16896
    s_waitcnt lgkmcnt(3)
    v_mfma_f32_16x16x32_bf16 v[36:39], v[84:87], v[68:71], v[36:39]
    ds_read_b128 v[60:63], v8 offset:51200
    s_waitcnt lgkmcnt(1)
    v_mfma_f32_16x16x32_bf16 v[32:35], v[72:75], v[56:59], v[32:35]
    ds_read_b128 v[64:67], v9 offset:49152
    ds_read_b64_tr_b16 v[84:85], v10 offset:20480
    ds_read_b64_tr_b16 v[86:87], v10 offset:20992
    s_waitcnt lgkmcnt(3)
    v_mfma_f32_16x16x32_bf16 v[36:39], v[72:75], v[60:63], v[36:39]
    ds_read_b128 v[68:71], v9 offset:51200
    s_waitcnt lgkmcnt(1)
    v_mfma_f32_16x16x32_bf16 v[32:35], v[84:87], v[64:67], v[32:35]
    ds_read_b128 v[56:59], v8 offset:57344
    ds_read_b64_tr_b16 v[72:73], v10 offset:24576
    ds_read_b64_tr_b16 v[74:75], v10 offset:25088
    s_waitcnt lgkmcnt(3)
    v_mfma_f32_16x16x32_bf16 v[36:39], v[84:87], v[68:71], v[36:39]
    ds_read_b128 v[60:63], v8 offset:59392
    s_waitcnt lgkmcnt(1)
    v_mfma_f32_16x16x32_bf16 v[32:35], v[72:75], v[56:59], v[32:35]
    ds_read_b128 v[64:67], v9 offset:57344
    ds_read_b64_tr_b16 v[84:85], v10 offset:28672
    ds_read_b64_tr_b16 v[86:87], v10 offset:29184
    s_waitcnt lgkmcnt(3)
    v_mfma_f32_16x16x32_bf16 v[36:39], v[72:75], v[60:63], v[36:39]
    ds_read_b128 v[68:71], v9 offset:59392
    s_waitcnt lgkmcnt(1)
    v_mfma_f32_16x16x32_bf16 v[32:35], v[84:87], v[64:67], v[32:35]
    s_waitcnt lgkmcnt(0)
    v_mfma_f32_16x16x32_bf16 v[36:39], v[84:87], v[68:71], v[36:39]
    s_cmp_lg_u32 s12, 0
    s_nop 6
    s_cbranch_scc1 K1_NT
    s_waitcnt vmcnt(0)
    v_readfirstlane_b32 s41, v249
    s_nop 0
    s_cmp_lg_u32 s41, 15
    s_nop 2
    s_cbranch_scc1 K1_NT
    v_lshlrev_b32 v248, 8, v1
    v_mov_b32 v249, 1
    s_mov_b32 s40, 10170368
    s_mov_b64 exec, 0xff
    buffer_atomic_add v249, v248, s[28:31], s40 offen
    s_mov_b64 exec, -1
K1_NT:
    s_mov_b32 s42, 0x3fb8aa3b
    s_mov_b32 s43, 0x3fb8aa3b
    v_pk_mul_f32 v[96:97], v[32:33], s[42:43]
    v_pk_mul_f32 v[98:99], v[34:35], s[42:43]
    v_pk_mul_f32 v[100:101], v[36:37], s[42:43]
    v_pk_mul_f32 v[102:103], v[38:39], s[42:43]
    v_exp_f32 v96, v96
    v_exp_f32 v97, v97
    v_exp_f32 v98, v98
    v_exp_f32 v99, v99
    v_exp_f32 v100, v100
    v_exp_f32 v101, v101
    v_exp_f32 v102, v102
    v_exp_f32 v103, v103
    v_pk_add_f32 v[104:105], v[32:33], s[58:59]
    v_pk_add_f32 v[106:107], v[34:35], s[58:59]
    v_pk_add_f32 v[108:109], v[36:37], s[58:59]
    v_pk_add_f32 v[110:111], v[38:39], s[58:59]
    v_cmp_lt_f32 s[60:61], 0, v32
    v_cmp_lt_f32 s[62:63], 0, v33
    s_nop 0
    v_cndmask_b32 v32, v96, v104, s[60:61]
    v_cndmask_b32 v33, v97, v105, s[62:63]
    v_cmp_lt_f32 s[60:61], 0, v34
    v_cmp_lt_f32 s[62:63], 0, v35
    s_nop 0
    v_cndmask_b32 v34, v98, v106, s[60:61]
    v_cndmask_b32 v35, v99, v107, s[62:63]
    v_cmp_lt_f32 s[60:61], 0, v36
    v_cmp_lt_f32 s[62:63], 0, v37
    s_nop 0
    v_cndmask_b32 v36, v100, v108, s[60:61]
    v_cndmask_b32 v37, v101, v109, s[62:63]
    v_cmp_lt_f32 s[60:61], 0, v38
    v_cmp_lt_f32 s[62:63], 0, v39
    s_nop 0
    v_cndmask_b32 v38, v102, v110, s[60:61]
    v_cndmask_b32 v39, v103, v111, s[62:63]
    v_pk_add_f32 v[32:33], v[32:33], s[56:57]
    v_pk_add_f32 v[34:35], v[34:35], s[56:57]
    v_pk_add_f32 v[36:37], v[36:37], s[56:57]
    v_pk_add_f32 v[38:39], v[38:39], s[56:57]
    v_cvt_pk_bf16_f32 v88, v32, v33
    v_cvt_pk_bf16_f32 v89, v34, v35
    v_cvt_pk_bf16_f32 v90, v36, v37
    v_cvt_pk_bf16_f32 v91, v38, v39
    s_lshl_b32 s40, s15, 12
    s_lshl_b32 s41, s55, 10
    s_add_u32 s40, s40, s41
    s_add_u32 s40, s40, 98304
    s_lshl_b32 s41, s54, 3
    s_add_u32 s41, s41, s40
    v_add_u32 v13, s41, v12
    ds_write_b64 v13, v[88:89]
    ds_write_b64 v13, v[90:91] offset:2048
    s_lshl_b32 s42, s13, 2
    s_lshl_b32 s43, s15, 1
    s_add_u32 s42, s42, s43
    s_add_u32 s42, s42, s54
    s_lshl_b32 s42, s42, 4
    s_lshl_b32 s43, s14, 1
    s_add_u32 s42, s42, s43
    s_add_u32 s42, s42, s55
    s_lshl_b32 s42, s42, 10
    s_add_u32 s42, s42, 65536
    s_waitcnt lgkmcnt(0)
    s_barrier
    s_lshl_b32 s41, s54, 11
    s_add_u32 s41, s41, s40
    v_add_u32 v13, s41, v12
    ds_read_b128 v[56:59], v13
    s_waitcnt lgkmcnt(0)
    buffer_store_dwordx4 v[56:59], v12, s[28:31], s42 offen sc1
    s_mov_b32 s79, s13
    s_waitcnt vmcnt(0) lgkmcnt(0)
    s_barrier
    s_cmp_lg_u32 s12, 0
    s_cbranch_scc1 KFS1_S
    s_mov_b32 s40, s79
    s_lshl_b32 s40, s40, 8
    s_add_u32 s40, s40, 10174464
    v_mov_b32 v248, 0
    v_mov_b32 v249, 1
    s_mov_b64 exec, 1
    buffer_atomic_add v249, v248, s[28:31], s40 offen
    s_mov_b64 exec, -1
KFS1_S:
    s_and_b32 s3, s2, 7
    s_lshl_b32 s13, s3, 2
    s_and_b32 s42, s17, 3
    s_add_u32 s13, s13, s42
    s_lshr_b32 s14, s17, 2
    s_and_b32 s18, s12, 3
    s_lshr_b32 s19, s12, 2
    s_lshl_b32 s15, s13, 2
    s_add_u32 s15, s15, s18
    s_lshl_b32 s76, s3, 1
    s_and_b32 s42, s17, 1
    s_add_u32 s76, s76, s42
    s_lshr_b32 s77, s17, 1
    s_mul_i32 s77, s77, 349528
    s_lshr_b32 s77, s77, 17
    v_lshlrev_b32 v5, 4, v1
    v_mul_u32_u24 v6, 1088, v3
    v_lshl_add_u32 v6, v2, 2, v6
    v_lshrrev_b32 v8, 3, v1
    v_mul_u32_u24 v8, 1024, v8
    v_and_b32 v9, 1, v3
    v_lshrrev_b32 v7, 5, v1
    v_lshl_add_u32 v9, v7, 2, v9
    v_and_b32 v7, 7, v1
    v_xor_b32 v9, v9, v7
    v_lshl_add_u32 v7, v9, 4, v8
    v_lshrrev_b32 v8, 2, v1
    v_mul_u32_u24 v8, 2752, v8
    v_and_b32 v9, 1, v3
    v_and_b32 v246, 3, v1
    v_xor_b32 v9, v9, v246
    v_lshl_add_u32 v246, v9, 4, v8
    v_lshrrev_b32 v8, 3, v1
    v_and_b32 v9, 7, v1
    v_lshlrev_b32 v9, 4, v9
    v_lshl_add_u32 v11, v8, 10, v9
    s_mov_b32 s24, s50
    s_and_b32 s25, s51, 0xffff
    s_mov_b32 s26, 524288
    s_mov_b32 s27, 0x20000
    s_mov_b32 s20, s4
    s_and_b32 s21, s5, 0xffff
    s_mov_b32 s22, 2097152
    s_mov_b32 s23, 0x20000
    s_mov_b32 s36, s68
    s_and_b32 s37, s69, 0xffff
    s_mov_b32 s38, 1409024
    s_mov_b32 s39, 0x20000
    s_lshl_b32 s43, s77, 6
    s_add_u32 s32, s70, s43
    s_addc_u32 s33, s71, 0
    s_and_b32 s33, s33, 0xffff
    s_mov_b32 s34, 192
    s_mov_b32 s35, 0x20000
    v_lshlrev_b32 v8, 1, v0
    buffer_load_ushort v244, v8, s[32:35], 0 offen
    v_lshrrev_b32 v8, 2, v2
    v_and_b32 v9, 3, v1
    v_and_b32 v10, 1, v3
    v_lshl_add_u32 v12, v3, 2, v8
    v_mov_b32 v13, v10
    v_lshlrev_b32 v12, 7, v12
    v_lshl_add_u32 v12, v13, 6, v12
    v_bfe_u32 v13, v2, 3, 1
    v_xor_b32 v13, v13, v9
    v_lshl_add_u32 v12, v13, 4, v12
    v_and_b32 v13, 1, v1
    v_lshl_add_u32 v12, v13, 3, v12
    v_xor_b32 v13, 8, v12
    v_lshl_add_u32 v14, v3, 2, v8
    v_add_u32 v14, 16, v14
    v_mov_b32 v15, v10
    v_lshlrev_b32 v14, 7, v14
    v_lshl_add_u32 v14, v15, 6, v14
    v_bfe_u32 v15, v2, 3, 1
    v_xor_b32 v15, v15, v9
    v_lshl_add_u32 v14, v15, 4, v14
    v_and_b32 v15, 1, v1
    v_lshl_add_u32 v14, v15, 3, v14
    v_xor_b32 v15, 8, v14
    s_lshl_b32 s41, s19, 12
    s_add_u32 s41, s41, 32768
    v_add_u32 v12, s41, v12
    v_xor_b32 v84, 64, v12
    v_add_u32 v13, s41, v13
    v_xor_b32 v85, 64, v13
    v_add_u32 v14, s41, v14
    v_xor_b32 v86, 64, v14
    v_add_u32 v15, s41, v15
    v_xor_b32 v87, 64, v15
    v_mov_b32 v88, 0
    v_mov_b32 v89, 0
    v_mov_b32 v90, 0
    v_mov_b32 v91, 0
    v_mov_b32 v92, 0
    v_mov_b32 v93, 0
    v_mov_b32 v94, 0
    v_mov_b32 v95, 0
    v_mov_b32 v96, 0
    v_mov_b32 v97, 0
    v_mov_b32 v98, 0
    v_mov_b32 v99, 0
    v_mov_b32 v100, 0
    v_mov_b32 v101, 0
    v_mov_b32 v102, 0
    v_mov_b32 v103, 0
    v_mov_b32 v8, 0
    v_and_b32 v9, 255, v0
    v_lshlrev_b32 v9, 2, v9
    ds_write_b32 v9, v8 offset:17408
    s_cmp_lg_u32 s12, 0
    s_nop 0
    s_cbranch_scc1 KFS1_W
    s_and_b32 s40, s2, 7
    s_lshl_b32 s40, s40, 8
    s_add_u32 s40, s40, 10170368
    v_mov_b32 v248, 0
    v_mov_b32 v247, 16
    s_lshl_b32 s41, s13, 8
    s_add_u32 s41, s41, 10174464
    s_sub_u32 s41, s41, s40
    v_writelane_b32 v248, s41, 1
    v_writelane_b32 v247, 8, 1
    s_mov_b64 exec, 3
    s_mov_b32 s43, 0
    s_nop 0
KFS1_P:
    buffer_load_dword v249, v248, s[28:31], s40 offen sc1
    s_add_u32 s43, s43, 1
    s_waitcnt vmcnt(0)
    v_cmp_gt_u32 vcc, v247, v249
    s_nop 4
    s_cbranch_vccz KFS1_X
    s_sleep 2
    s_cmp_lt_u32 s43, 0x40000
    s_cbranch_scc1 KFS1_P
KFS1_X:
    s_mov_b64 exec, -1
    s_branch KFS1_E
KFS1_W:
    s_lshl_b32 s43, s14, 7
    s_sub_u32 s52, s12, 1
LWO:
    s_lshl_b32 s49, s52, 13
    s_add_u32 s49, s49, s43
    s_lshl_b32 s41, s52, 10
    s_add_u32 m0, s41, 32768
    s_nop 0
    buffer_load_dwordx4 v7, s[24:27], s49 offen lds
    s_add_u32 s52, s52, 7
    s_cmp_lt_u32 s52, 64
    s_cbranch_scc1 LWO
    s_sub_u32 s52, s12, 1
LXT:
    s_lshl_b32 s40, s13, 16
    s_lshl_b32 s41, s52, 13
    s_add_u32 s40, s40, s41
    s_add_u32 s40, s40, s43
    s_lshl_b32 s41, s52, 10
    s_add_u32 m0, s41, 24576
    s_nop 0
    buffer_load_dwordx4 v11, s[20:23], s40 offen lds
    s_add_u32 s52, s52, 7
    s_cmp_lt_u32 s52, 8
    s_cbranch_scc1 LXT
KFS1_E:
    s_waitcnt lgkmcnt(0)
    s_barrier
    s_mul_i32 s47, s12, 4352
    s_lshl_b32 s40, s15, 14
    s_lshl_b32 s41, s19, 10
    s_add_u32 s40, s40, s41
    s_add_u32 s40, s40, 65536
    buffer_load_dwordx4 v[16:19], v5, s[28:31], s47 offen offset:0 sc1
    buffer_load_dwordx4 v[20:23], v5, s[28:31], s47 offen offset:1088 sc1
    buffer_load_dwordx4 v[24:27], v5, s[28:31], s47 offen offset:2176 sc1
    buffer_load_dwordx4 v[28:31], v5, s[28:31], s47 offen offset:3264 sc1
    buffer_load_dword v32, v6, s[28:31], s47 offen offset:1024 sc1
    buffer_load_dwordx4 v[48:51], v5, s[28:31], s40 offen offset:0 sc1
    buffer_load_dwordx4 v[52:55], v5, s[28:31], s40 offen offset:2048 sc1
    s_add_u32 s40, s40, 4096
    buffer_load_dwordx4 v[56:59], v5, s[28:31], s40 offen offset:0 sc1
    buffer_load_dwordx4 v[60:63], v5, s[28:31], s40 offen offset:2048 sc1
    s_add_u32 s40, s40, 4096
    buffer_load_dwordx4 v[64:67], v5, s[28:31], s40 offen offset:0 sc1
    buffer_load_dwordx4 v[68:71], v5, s[28:31], s40 offen offset:2048 sc1
    s_add_u32 s40, s40, 4096
    buffer_load_dwordx4 v[72:75], v5, s[28:31], s40 offen offset:0 sc1
    buffer_load_dwordx4 v[76:79], v5, s[28:31], s40 offen offset:2048 sc1
    s_add_u32 s40, s40, 4096
    s_lshl_b32 s44, s77, 7
    s_add_u32 s44, s44, 36864
    s_add_u32 s32, s10, s44
    s_addc_u32 s33, s11, 0
    s_and_b32 s33, s33, 0xffff
    s_mov_b32 s34, 384
    s_mov_b32 s35, 0x20000
    v_lshlrev_b32 v9, 2, v0
    buffer_load_dword v245, v9, s[32:35], 0 offen sc1
    s_waitcnt vmcnt(9)
    s_lshl_b32 s40, s12, 11
    v_add_u32 v8, s40, v5
    v_cvt_pk_bf16_f32 v36, v16, v17
    v_cvt_pk_bf16_f32 v37, v18, v19
    v_cvt_pk_bf16_f32 v38, v20, v21
    v_cvt_pk_bf16_f32 v39, v22, v23
    v_cvt_pk_bf16_f32 v40, v24, v25
    v_cvt_pk_bf16_f32 v41, v26, v27
    v_cvt_pk_bf16_f32 v42, v28, v29
    v_cvt_pk_bf16_f32 v43, v30, v31
    ds_write_b128 v8, v[36:39] offset:0
    ds_write_b128 v8, v[40:43] offset:1024
    v_cvt_pk_bf16_f32 v32, v32, v32
    s_lshl_b32 s40, s12, 7
    v_lshlrev_b32 v9, 1, v1
    v_add_u32 v9, s40, v9
    ds_write_b16 v9, v32 offset:16384
    s_waitcnt vmcnt(5)
    s_waitcnt lgkmcnt(0)
    s_barrier
    s_lshl_b32 s41, s19, 10
    v_add_u32 v8, s41, v5
    s_lshl_b32 s41, s19, 6
    v_lshlrev_b32 v9, 3, v3
    v_add_u32 v9, s41, v9
    v_and_b32 v10, 1, v1
    v_lshlrev_b32 v10, 10, v10
    v_add_u32 v6, v9, v10
    v_xor_b32 v10, 1024, v10
    v_add_u32 v11, v9, v10
    s_mov_b32 s48, 0x358637bd
    ds_read_b128 v[104:107], v8 offset:0
    ds_read_b64 v[136:137], v6 offset:16384
    ds_read_b64 v[138:139], v11 offset:16416
    ds_read_b128 v[108:111], v8 offset:2048
    ds_read_b64 v[140:141], v6 offset:16512
    ds_read_b64 v[142:143], v11 offset:16544
    ds_read_b128 v[112:115], v8 offset:4096
    ds_read_b64 v[144:145], v6 offset:16640
    ds_read_b64 v[146:147], v11 offset:16672
    ds_read_b128 v[116:119], v8 offset:6144
    ds_read_b64 v[148:149], v6 offset:16768
    ds_read_b64 v[150:151], v11 offset:16800
    ds_read_b128 v[120:123], v8 offset:8192
    ds_read_b64 v[152:153], v6 offset:16896
    ds_read_b64 v[154:155], v11 offset:16928
    s_waitcnt lgkmcnt(12)
    v_mfma_f32_16x16x16_bf16 v[168:171], v[104:105], v[48:49], 0
    v_mfma_f32_16x16x16_bf16 v[172:175], v[106:107], v[50:51], 0
    v_mfma_f32_16x16x32_bf16 v[16:19], v[136:139], v[48:51], 0
    ds_read_b128 v[124:127], v8 offset:10240
    ds_read_b64 v[156:157], v6 offset:17024
    ds_read_b64 v[158:159], v11 offset:17056
    s_waitcnt lgkmcnt(12)
    v_mfma_f32_16x16x16_bf16 v[176:179], v[108:109], v[52:53], 0
    v_mfma_f32_16x16x16_bf16 v[180:183], v[110:111], v[54:55], 0
    v_mfma_f32_16x16x32_bf16 v[20:23], v[140:143], v[52:55], 0
    ds_read_b128 v[128:131], v8 offset:12288
    ds_read_b64 v[160:161], v6 offset:17152
    ds_read_b64 v[162:163], v11 offset:17184
    s_waitcnt lgkmcnt(12)
    v_mfma_f32_16x16x16_bf16 v[184:187], v[112:113], v[56:57], 0
    v_mfma_f32_16x16x16_bf16 v[188:191], v[114:115], v[58:59], 0
    v_mfma_f32_16x16x32_bf16 v[24:27], v[144:147], v[56:59], 0
    ds_read_b128 v[132:135], v8 offset:14336
    ds_read_b64 v[164:165], v6 offset:17280
    ds_read_b64 v[166:167], v11 offset:17312
    s_waitcnt lgkmcnt(12)
    v_mfma_f32_16x16x16_bf16 v[192:195], v[116:117], v[60:61], 0
    v_mfma_f32_16x16x16_bf16 v[196:199], v[118:119], v[62:63], 0
    v_mfma_f32_16x16x32_bf16 v[28:31], v[148:151], v[60:63], 0
    s_waitcnt vmcnt(1)
    s_waitcnt lgkmcnt(9)
    v_mfma_f32_16x16x16_bf16 v[200:203], v[120:121], v[64:65], 0
    v_mfma_f32_16x16x16_bf16 v[204:207], v[122:123], v[66:67], 0
    v_mfma_f32_16x16x32_bf16 v[32:35], v[152:155], v[64:67], 0
    s_waitcnt lgkmcnt(6)
    v_mfma_f32_16x16x16_bf16 v[208:211], v[124:125], v[68:69], 0
    v_mfma_f32_16x16x16_bf16 v[212:215], v[126:127], v[70:71], 0
    v_mfma_f32_16x16x32_bf16 v[36:39], v[156:159], v[68:71], 0
    s_waitcnt lgkmcnt(3)
    v_mfma_f32_16x16x16_bf16 v[216:219], v[128:129], v[72:73], 0
    v_mfma_f32_16x16x16_bf16 v[220:223], v[130:131], v[74:75], 0
    v_mfma_f32_16x16x32_bf16 v[40:43], v[160:163], v[72:75], 0
    s_waitcnt lgkmcnt(0)
    v_mfma_f32_16x16x16_bf16 v[224:227], v[132:133], v[76:77], 0
    v_mfma_f32_16x16x16_bf16 v[228:231], v[134:135], v[78:79], 0
    v_mfma_f32_16x16x32_bf16 v[44:47], v[164:167], v[76:79], 0
    ds_read_b64_tr_b16 v[104:105], v12 offset:0
    ds_read_b64_tr_b16 v[106:107], v14 offset:0
    ds_read_b64_tr_b16 v[108:109], v13 offset:0
    ds_read_b64_tr_b16 v[110:111], v15 offset:0
    ds_read_b64_tr_b16 v[112:113], v84 offset:0
    ds_read_b64_tr_b16 v[114:115], v86 offset:0
    ds_read_b64_tr_b16 v[116:117], v85 offset:0
    ds_read_b64_tr_b16 v[118:119], v87 offset:0
    s_add_u32 s52, s12, 0
    s_mul_i32 s49, s52, 44032
    s_lshl_b32 s44, s77, 6
    s_add_u32 s49, s49, s44
    s_lshl_b32 s41, s52, 10
    s_add_u32 m0, s41, 98304
    s_nop 0
    buffer_load_dwordx4 v246, s[36:39], s49 offen offset:0 lds
    s_add_u32 m0, s41, 114624
    s_nop 0
    buffer_load_dwordx4 v246, s[36:39], s49 offen offset:64 lds
    s_add_u32 m0, s41, 130944
    s_nop 0
    buffer_load_dwordx4 v246, s[36:39], s49 offen offset:128 lds
    s_add_u32 s52, s12, 8
    s_mul_i32 s49, s52, 44032
    s_lshl_b32 s44, s77, 6
    s_add_u32 s49, s49, s44
    s_lshl_b32 s41, s52, 10
    s_add_u32 m0, s41, 98304
    s_nop 0
    buffer_load_dwordx4 v246, s[36:39], s49 offen offset:0 lds
    s_add_u32 m0, s41, 114624
    s_nop 0
    buffer_load_dwordx4 v246, s[36:39], s49 offen offset:64 lds
    s_add_u32 m0, s41, 130944
    s_nop 0
    buffer_load_dwordx4 v246, s[36:39], s49 offen offset:128 lds
    s_mov_b32 s32, s72
    s_and_b32 s33, s73, 0xffff
    s_mov_b32 s34, 1409024
    s_mov_b32 s35, 0x20000
    s_mul_i32 s44, s17, 44032
    s_mul_i32 s45, s12, 6144
    s_add_u32 s44, s44, s45
    buffer_load_dwordx4 v[250:253], v5, s[32:35], s44 offen offset:0
    buffer_load_dwordx4 v[250:253], v5, s[32:35], s44 offen offset:1024
    buffer_load_dwordx4 v[250:253], v5, s[32:35], s44 offen offset:2048
    buffer_load_dwordx4 v[250:253], v5, s[32:35], s44 offen offset:3072
    s_add_u32 s44, s44, 4096
    buffer_load_dwordx4 v[250:253], v5, s[32:35], s44 offen offset:0
    buffer_load_dwordx4 v[250:253], v5, s[32:35], s44 offen offset:1024
    v_add_f32 v16, s48, v16
    v_add_f32 v17, s48, v17
    v_rcp_f32 v16, v16
    v_rcp_f32 v17, v17
    s_nop 0
    v_pk_mul_f32 v[168:169], v[168:169], v[16:17] op_sel:[0,0] op_sel_hi:[1,0]
    v_pk_mul_f32 v[170:171], v[170:171], v[16:17] op_sel:[0,0] op_sel_hi:[1,0]
    v_pk_mul_f32 v[172:173], v[172:173], v[16:17] op_sel:[0,1] op_sel_hi:[1,1]
    v_pk_mul_f32 v[174:175], v[174:175], v[16:17] op_sel:[0,1] op_sel_hi:[1,1]
    v_cvt_pk_bf16_f32 v48, v168, v169
    v_cvt_pk_bf16_f32 v49, v170, v171
    v_cvt_pk_bf16_f32 v50, v172, v173
    v_cvt_pk_bf16_f32 v51, v174, v175
    v_add_f32 v20, s48, v20
    v_add_f32 v21, s48, v21
    v_rcp_f32 v20, v20
    v_rcp_f32 v21, v21
    s_nop 0
    v_pk_mul_f32 v[176:177], v[176:177], v[20:21] op_sel:[0,0] op_sel_hi:[1,0]
    v_pk_mul_f32 v[178:179], v[178:179], v[20:21] op_sel:[0,0] op_sel_hi:[1,0]
    v_pk_mul_f32 v[180:181], v[180:181], v[20:21] op_sel:[0,1] op_sel_hi:[1,1]
    v_pk_mul_f32 v[182:183], v[182:183], v[20:21] op_sel:[0,1] op_sel_hi:[1,1]
    v_cvt_pk_bf16_f32 v52, v176, v177
    v_cvt_pk_bf16_f32 v53, v178, v179
    v_cvt_pk_bf16_f32 v54, v180, v181
    v_cvt_pk_bf16_f32 v55, v182, v183
    v_add_f32 v24, s48, v24
    v_add_f32 v25, s48, v25
    v_rcp_f32 v24, v24
    v_rcp_f32 v25, v25
    s_nop 0
    v_pk_mul_f32 v[184:185], v[184:185], v[24:25] op_sel:[0,0] op_sel_hi:[1,0]
    v_pk_mul_f32 v[186:187], v[186:187], v[24:25] op_sel:[0,0] op_sel_hi:[1,0]
    v_pk_mul_f32 v[188:189], v[188:189], v[24:25] op_sel:[0,1] op_sel_hi:[1,1]
    v_pk_mul_f32 v[190:191], v[190:191], v[24:25] op_sel:[0,1] op_sel_hi:[1,1]
    v_cvt_pk_bf16_f32 v56, v184, v185
    v_cvt_pk_bf16_f32 v57, v186, v187
    v_cvt_pk_bf16_f32 v58, v188, v189
    v_cvt_pk_bf16_f32 v59, v190, v191
    v_add_f32 v28, s48, v28
    v_add_f32 v29, s48, v29
    v_rcp_f32 v28, v28
    v_rcp_f32 v29, v29
    s_nop 0
    v_pk_mul_f32 v[192:193], v[192:193], v[28:29] op_sel:[0,0] op_sel_hi:[1,0]
    v_pk_mul_f32 v[194:195], v[194:195], v[28:29] op_sel:[0,0] op_sel_hi:[1,0]
    v_pk_mul_f32 v[196:197], v[196:197], v[28:29] op_sel:[0,1] op_sel_hi:[1,1]
    v_pk_mul_f32 v[198:199], v[198:199], v[28:29] op_sel:[0,1] op_sel_hi:[1,1]
    v_cvt_pk_bf16_f32 v60, v192, v193
    v_cvt_pk_bf16_f32 v61, v194, v195
    v_cvt_pk_bf16_f32 v62, v196, v197
    v_cvt_pk_bf16_f32 v63, v198, v199
    v_add_f32 v32, s48, v32
    v_add_f32 v33, s48, v33
    v_rcp_f32 v32, v32
    v_rcp_f32 v33, v33
    s_nop 0
    v_pk_mul_f32 v[200:201], v[200:201], v[32:33] op_sel:[0,0] op_sel_hi:[1,0]
    v_pk_mul_f32 v[202:203], v[202:203], v[32:33] op_sel:[0,0] op_sel_hi:[1,0]
    v_pk_mul_f32 v[204:205], v[204:205], v[32:33] op_sel:[0,1] op_sel_hi:[1,1]
    v_pk_mul_f32 v[206:207], v[206:207], v[32:33] op_sel:[0,1] op_sel_hi:[1,1]
    v_cvt_pk_bf16_f32 v64, v200, v201
    v_cvt_pk_bf16_f32 v65, v202, v203
    v_cvt_pk_bf16_f32 v66, v204, v205
    v_cvt_pk_bf16_f32 v67, v206, v207
    v_add_f32 v36, s48, v36
    v_add_f32 v37, s48, v37
    v_rcp_f32 v36, v36
    v_rcp_f32 v37, v37
    s_nop 0
    v_pk_mul_f32 v[208:209], v[208:209], v[36:37] op_sel:[0,0] op_sel_hi:[1,0]
    v_pk_mul_f32 v[210:211], v[210:211], v[36:37] op_sel:[0,0] op_sel_hi:[1,0]
    v_pk_mul_f32 v[212:213], v[212:213], v[36:37] op_sel:[0,1] op_sel_hi:[1,1]
    v_pk_mul_f32 v[214:215], v[214:215], v[36:37] op_sel:[0,1] op_sel_hi:[1,1]
    v_cvt_pk_bf16_f32 v68, v208, v209
    v_cvt_pk_bf16_f32 v69, v210, v211
    v_cvt_pk_bf16_f32 v70, v212, v213
    v_cvt_pk_bf16_f32 v71, v214, v215
    v_add_f32 v40, s48, v40
    v_add_f32 v41, s48, v41
    v_rcp_f32 v40, v40
    v_rcp_f32 v41, v41
    s_nop 0
    v_pk_mul_f32 v[216:217], v[216:217], v[40:41] op_sel:[0,0] op_sel_hi:[1,0]
    v_pk_mul_f32 v[218:219], v[218:219], v[40:41] op_sel:[0,0] op_sel_hi:[1,0]
    v_pk_mul_f32 v[220:221], v[220:221], v[40:41] op_sel:[0,1] op_sel_hi:[1,1]
    v_pk_mul_f32 v[222:223], v[222:223], v[40:41] op_sel:[0,1] op_sel_hi:[1,1]
    v_cvt_pk_bf16_f32 v72, v216, v217
    v_cvt_pk_bf16_f32 v73, v218, v219
    v_cvt_pk_bf16_f32 v74, v220, v221
    v_cvt_pk_bf16_f32 v75, v222, v223
    v_add_f32 v44, s48, v44
    v_add_f32 v45, s48, v45
    v_rcp_f32 v44, v44
    v_rcp_f32 v45, v45
    s_nop 0
    v_pk_mul_f32 v[224:225], v[224:225], v[44:45] op_sel:[0,0] op_sel_hi:[1,0]
    v_pk_mul_f32 v[226:227], v[226:227], v[44:45] op_sel:[0,0] op_sel_hi:[1,0]
    v_pk_mul_f32 v[228:229], v[228:229], v[44:45] op_sel:[0,1] op_sel_hi:[1,1]
    v_pk_mul_f32 v[230:231], v[230:231], v[44:45] op_sel:[0,1] op_sel_hi:[1,1]
    v_cvt_pk_bf16_f32 v76, v224, v225
    v_cvt_pk_bf16_f32 v77, v226, v227
    v_cvt_pk_bf16_f32 v78, v228, v229
    v_cvt_pk_bf16_f32 v79, v230, v231
    s_waitcnt lgkmcnt(6)
    v_mfma_f32_16x16x32_bf16 v[88:91], v[104:107], v[48:51], v[88:91]
    ds_read_b64_tr_b16 v[120:121], v12 offset:8192
    ds_read_b64_tr_b16 v[122:123], v14 offset:8192
    s_waitcnt lgkmcnt(6)
    v_mfma_f32_16x16x32_bf16 v[92:95], v[108:111], v[48:51], v[92:95]
    ds_read_b64_tr_b16 v[124:125], v13 offset:8192
    ds_read_b64_tr_b16 v[126:127], v15 offset:8192
    s_waitcnt lgkmcnt(6)
    v_mfma_f32_16x16x32_bf16 v[96:99], v[112:115], v[48:51], v[96:99]
    ds_read_b64_tr_b16 v[128:129], v84 offset:8192
    ds_read_b64_tr_b16 v[130:131], v86 offset:8192
    s_waitcnt lgkmcnt(6)
    v_mfma_f32_16x16x32_bf16 v[100:103], v[116:119], v[48:51], v[100:103]
    ds_read_b64_tr_b16 v[132:133], v85 offset:8192
    ds_read_b64_tr_b16 v[134:135], v87 offset:8192
    s_waitcnt lgkmcnt(6)
    v_mfma_f32_16x16x32_bf16 v[88:91], v[120:123], v[52:55], v[88:91]
    ds_read_b64_tr_b16 v[104:105], v12 offset:16384
    ds_read_b64_tr_b16 v[106:107], v14 offset:16384
    s_waitcnt lgkmcnt(6)
    v_mfma_f32_16x16x32_bf16 v[92:95], v[124:127], v[52:55], v[92:95]
    ds_read_b64_tr_b16 v[108:109], v13 offset:16384
    ds_read_b64_tr_b16 v[110:111], v15 offset:16384
    s_waitcnt lgkmcnt(6)
    v_mfma_f32_16x16x32_bf16 v[96:99], v[128:131], v[52:55], v[96:99]
    ds_read_b64_tr_b16 v[112:113], v84 offset:16384
    ds_read_b64_tr_b16 v[114:115], v86 offset:16384
    s_waitcnt lgkmcnt(6)
    v_mfma_f32_16x16x32_bf16 v[100:103], v[132:135], v[52:55], v[100:103]
    ds_read_b64_tr_b16 v[116:117], v85 offset:16384
    ds_read_b64_tr_b16 v[118:119], v87 offset:16384
    s_waitcnt lgkmcnt(6)
    v_mfma_f32_16x16x32_bf16 v[88:91], v[104:107], v[56:59], v[88:91]
    ds_read_b64_tr_b16 v[120:121], v12 offset:24576
    ds_read_b64_tr_b16 v[122:123], v14 offset:24576
    s_waitcnt lgkmcnt(6)
    v_mfma_f32_16x16x32_bf16 v[92:95], v[108:111], v[56:59], v[92:95]
    ds_read_b64_tr_b16 v[124:125], v13 offset:24576
    ds_read_b64_tr_b16 v[126:127], v15 offset:24576
    s_waitcnt lgkmcnt(6)
    v_mfma_f32_16x16x32_bf16 v[96:99], v[112:115], v[56:59], v[96:99]
    ds_read_b64_tr_b16 v[128:129], v84 offset:24576
    ds_read_b64_tr_b16 v[130:131], v86 offset:24576
    s_waitcnt lgkmcnt(6)
    v_mfma_f32_16x16x32_bf16 v[100:103], v[116:119], v[56:59], v[100:103]
    ds_read_b64_tr_b16 v[132:133], v85 offset:24576
    ds_read_b64_tr_b16 v[134:135], v87 offset:24576
    s_waitcnt lgkmcnt(6)
    v_mfma_f32_16x16x32_bf16 v[88:91], v[120:123], v[60:63], v[88:91]
    ds_read_b64_tr_b16 v[104:105], v12 offset:32768
    ds_read_b64_tr_b16 v[106:107], v14 offset:32768
    s_waitcnt lgkmcnt(6)
    v_mfma_f32_16x16x32_bf16 v[92:95], v[124:127], v[60:63], v[92:95]
    ds_read_b64_tr_b16 v[108:109], v13 offset:32768
    ds_read_b64_tr_b16 v[110:111], v15 offset:32768
    s_waitcnt lgkmcnt(6)
    v_mfma_f32_16x16x32_bf16 v[96:99], v[128:131], v[60:63], v[96:99]
    ds_read_b64_tr_b16 v[112:113], v84 offset:32768
    ds_read_b64_tr_b16 v[114:115], v86 offset:32768
    s_waitcnt lgkmcnt(6)
    v_mfma_f32_16x16x32_bf16 v[100:103], v[132:135], v[60:63], v[100:103]
    ds_read_b64_tr_b16 v[116:117], v85 offset:32768
    ds_read_b64_tr_b16 v[118:119], v87 offset:32768
    s_waitcnt lgkmcnt(6)
    v_mfma_f32_16x16x32_bf16 v[88:91], v[104:107], v[64:67], v[88:91]
    ds_read_b64_tr_b16 v[120:121], v12 offset:40960
    ds_read_b64_tr_b16 v[122:123], v14 offset:40960
    s_waitcnt lgkmcnt(6)
    v_mfma_f32_16x16x32_bf16 v[92:95], v[108:111], v[64:67], v[92:95]
    ds_read_b64_tr_b16 v[124:125], v13 offset:40960
    ds_read_b64_tr_b16 v[126:127], v15 offset:40960
    s_waitcnt lgkmcnt(6)
    v_mfma_f32_16x16x32_bf16 v[96:99], v[112:115], v[64:67], v[96:99]
    ds_read_b64_tr_b16 v[128:129], v84 offset:40960
    ds_read_b64_tr_b16 v[130:131], v86 offset:40960
    s_waitcnt lgkmcnt(6)
    v_mfma_f32_16x16x32_bf16 v[100:103], v[116:119], v[64:67], v[100:103]
    ds_read_b64_tr_b16 v[132:133], v85 offset:40960
    ds_read_b64_tr_b16 v[134:135], v87 offset:40960
    s_waitcnt lgkmcnt(6)
    v_mfma_f32_16x16x32_bf16 v[88:91], v[120:123], v[68:71], v[88:91]
    ds_read_b64_tr_b16 v[104:105], v12 offset:49152
    ds_read_b64_tr_b16 v[106:107], v14 offset:49152
    s_waitcnt lgkmcnt(6)
    v_mfma_f32_16x16x32_bf16 v[92:95], v[124:127], v[68:71], v[92:95]
    ds_read_b64_tr_b16 v[108:109], v13 offset:49152
    ds_read_b64_tr_b16 v[110:111], v15 offset:49152
    s_waitcnt lgkmcnt(6)
    v_mfma_f32_16x16x32_bf16 v[96:99], v[128:131], v[68:71], v[96:99]
    ds_read_b64_tr_b16 v[112:113], v84 offset:49152
    ds_read_b64_tr_b16 v[114:115], v86 offset:49152
    s_waitcnt lgkmcnt(6)
    v_mfma_f32_16x16x32_bf16 v[100:103], v[132:135], v[68:71], v[100:103]
    ds_read_b64_tr_b16 v[116:117], v85 offset:49152
    ds_read_b64_tr_b16 v[118:119], v87 offset:49152
    s_waitcnt lgkmcnt(6)
    v_mfma_f32_16x16x32_bf16 v[88:91], v[104:107], v[72:75], v[88:91]
    ds_read_b64_tr_b16 v[120:121], v12 offset:57344
    ds_read_b64_tr_b16 v[122:123], v14 offset:57344
    s_waitcnt lgkmcnt(6)
    v_mfma_f32_16x16x32_bf16 v[92:95], v[108:111], v[72:75], v[92:95]
    ds_read_b64_tr_b16 v[124:125], v13 offset:57344
    ds_read_b64_tr_b16 v[126:127], v15 offset:57344
    s_waitcnt lgkmcnt(6)
    v_mfma_f32_16x16x32_bf16 v[96:99], v[112:115], v[72:75], v[96:99]
    ds_read_b64_tr_b16 v[128:129], v84 offset:57344
    ds_read_b64_tr_b16 v[130:131], v86 offset:57344
    s_waitcnt lgkmcnt(6)
    v_mfma_f32_16x16x32_bf16 v[100:103], v[116:119], v[72:75], v[100:103]
    ds_read_b64_tr_b16 v[132:133], v85 offset:57344
    ds_read_b64_tr_b16 v[134:135], v87 offset:57344
    s_waitcnt lgkmcnt(6)
    v_mfma_f32_16x16x32_bf16 v[88:91], v[120:123], v[76:79], v[88:91]
    s_waitcnt lgkmcnt(4)
    v_mfma_f32_16x16x32_bf16 v[92:95], v[124:127], v[76:79], v[92:95]
    s_waitcnt lgkmcnt(2)
    v_mfma_f32_16x16x32_bf16 v[96:99], v[128:131], v[76:79], v[96:99]
    s_waitcnt lgkmcnt(0)
    v_mfma_f32_16x16x32_bf16 v[100:103], v[132:135], v[76:79], v[100:103]
    s_lshl_b32 s40, s18, 12
    s_add_u32 s40, s40, 147456
    s_xor_b32 s41, s19, 1
    s_lshl_b32 s41, s41, 11
    s_add_u32 s41, s41, s40
    v_add_u32 v8, s41, v5
    s_cmp_eq_u32 s19, 0
    s_nop 1
    s_cbranch_scc0 KF2_R1
    ds_write_b128 v8, v[96:99]
    ds_write_b128 v8, v[100:103] offset:1024
    s_branch KF2_R2
KF2_R1:
    ds_write_b128 v8, v[88:91]
    ds_write_b128 v8, v[92:95] offset:1024
    v_pk_mov_b32 v[88:89], v[96:97], v[96:97] op_sel:[0,1]
    v_pk_mov_b32 v[90:91], v[98:99], v[98:99] op_sel:[0,1]
    v_pk_mov_b32 v[92:93], v[100:101], v[100:101] op_sel:[0,1]
    v_pk_mov_b32 v[94:95], v[102:103], v[102:103] op_sel:[0,1]
    s_nop 2
KF2_R2:
    s_lshl_b32 s41, s18, 11
    s_lshl_b32 s42, s19, 6
    s_add_u32 s41, s41, s42
    v_and_b32 v9, 1, v3
    v_lshlrev_b32 v9, 3, v9
    v_lshl_add_u32 v9, v3, 4, v9
    v_lshl_add_u32 v9, v2, 7, v9
    v_add_u32 v9, s41, v9
    v_xor_b32 v10, 8, v9
    ds_read_b64 v[80:81], v9 offset:24576
    ds_read_b64 v[82:83], v10 offset:24576
    s_waitcnt lgkmcnt(0)
    s_barrier
    s_lshl_b32 s41, s19, 11
    s_add_u32 s41, s41, s40
    v_add_u32 v8, s41, v5
    ds_read_b128 v[16:19], v8
    ds_read_b128 v[20:23], v8 offset:1024
    s_lshl_b32 s40, s15, 4
    s_lshl_b32 s41, s14, 1
    s_add_u32 s41, s41, s19
    s_add_u32 s40, s40, s41
    s_lshl_b32 s40, s40, 10
    s_add_u32 s40, s40, 2162688
    v_mov_b32 v28, 0
    v_mov_b32 v29, 0
    v_mov_b32 v30, 1.0
    v_lshlrev_b32 v32, 16, v80
    v_and_b32 v33, 0xffff0000, v80
    v_pk_add_f32 v[32:33], v[32:33], v[88:89]
    v_lshlrev_b32 v34, 16, v81
    v_and_b32 v35, 0xffff0000, v81
    v_pk_add_f32 v[34:35], v[34:35], v[90:91]
    v_lshlrev_b32 v36, 16, v82
    v_and_b32 v37, 0xffff0000, v82
    v_pk_add_f32 v[36:37], v[36:37], v[92:93]
    v_lshlrev_b32 v38, 16, v83
    v_and_b32 v39, 0xffff0000, v83
    v_pk_add_f32 v[38:39], v[38:39], v[94:95]
    s_waitcnt lgkmcnt(0)
    v_pk_add_f32 v[32:33], v[32:33], v[16:17]
    v_cvt_pk_bf16_f32 v240, v32, v33
    v_pk_add_f32 v[34:35], v[34:35], v[18:19]
    v_cvt_pk_bf16_f32 v241, v34, v35
    v_pk_add_f32 v[36:37], v[36:37], v[20:21]
    v_cvt_pk_bf16_f32 v242, v36, v37
    v_pk_add_f32 v[38:39], v[38:39], v[22:23]
    v_cvt_pk_bf16_f32 v243, v38, v39
    buffer_store_dwordx4 v[240:243], v5, s[28:31], s40 offen sc1
    v_lshlrev_b32 v9, 16, v240
    v_and_b32 v10, 0xffff0000, v240
    v_add_f32 v28, v28, v9
    v_fma_f32 v29, v9, v9, v29
    v_add_f32 v28, v28, v10
    v_fma_f32 v29, v10, v10, v29
    v_lshlrev_b32 v9, 16, v241
    v_and_b32 v10, 0xffff0000, v241
    v_add_f32 v28, v28, v9
    v_fma_f32 v29, v9, v9, v29
    v_add_f32 v28, v28, v10
    v_fma_f32 v29, v10, v10, v29
    v_lshlrev_b32 v9, 16, v242
    v_and_b32 v10, 0xffff0000, v242
    v_add_f32 v28, v28, v9
    v_fma_f32 v29, v9, v9, v29
    v_add_f32 v28, v28, v10
    v_fma_f32 v29, v10, v10, v29
    v_lshlrev_b32 v9, 16, v243
    v_and_b32 v10, 0xffff0000, v243
    v_add_f32 v28, v28, v9
    v_fma_f32 v29, v9, v9, v29
    v_add_f32 v28, v28, v10
    v_fma_f32 v29, v10, v10, v29
    s_nop 0
    v_mfma_f32_16x16x4_f32 v[32:35], v30, v28, 0
    v_mfma_f32_16x16x4_f32 v[36:39], v30, v29, 0
    s_lshl_b32 s40, s15, 11
    s_bfe_u32 s42, s41, 0x10001
    s_lshl_b32 s42, s42, 10
    s_add_u32 s40, s40, s42
    s_lshr_b32 s42, s41, 2
    s_lshl_b32 s42, s42, 8
    s_add_u32 s40, s40, s42
    s_and_b32 s42, s41, 1
    s_lshl_b32 s42, s42, 3
    s_add_u32 s40, s40, s42
    s_add_u32 s40, s40, 9895936
    v_mov_b32 v33, v36
    s_mov_b64 exec, 0xffff
    buffer_store_dwordx2 v[32:33], v5, s[28:31], s40 offen sc1
    s_mov_b64 exec, -1
    s_lshl_b32 s78, s76, 3
    s_lshl_b32 s40, s18, 1
    s_add_u32 s78, s78, s40
    s_add_u32 s16, s78, s19
    s_lshl_b32 s46, s78, 14
    s_lshl_b32 s40, s19, 10
    s_add_u32 s46, s46, s40
    s_add_u32 s46, s46, 2162688
    s_add_u32 s48, s46, 16384
    s_waitcnt vmcnt(14)
    s_waitcnt lgkmcnt(0)
    s_barrier
    s_add_u32 s52, s12, 0
    s_mul_i32 s49, s52, 44032
    s_lshl_b32 s44, s77, 6
    s_add_u32 s49, s49, s44
    s_add_u32 s49, s49, 704512
    s_lshl_b32 s41, s52, 10
    s_add_u32 m0, s41, 49152
    s_nop 0
    buffer_load_dwordx4 v246, s[36:39], s49 offen offset:0 lds
    s_add_u32 m0, s41, 65472
    s_nop 0
    buffer_load_dwordx4 v246, s[36:39], s49 offen offset:64 lds
    s_add_u32 m0, s41, 81792
    s_nop 0
    buffer_load_dwordx4 v246, s[36:39], s49 offen offset:128 lds
    s_add_u32 s52, s12, 8
    s_mul_i32 s49, s52, 44032
    s_lshl_b32 s44, s77, 6
    s_add_u32 s49, s49, s44
    s_add_u32 s49, s49, 704512
    s_lshl_b32 s41, s52, 10
    s_add_u32 m0, s41, 49152
    s_nop 0
    buffer_load_dwordx4 v246, s[36:39], s49 offen offset:0 lds
    s_add_u32 m0, s41, 65472
    s_nop 0
    buffer_load_dwordx4 v246, s[36:39], s49 offen offset:64 lds
    s_add_u32 m0, s41, 81792
    s_nop 0
    buffer_load_dwordx4 v246, s[36:39], s49 offen offset:128 lds
    s_add_u32 s47, s46, 0
    buffer_load_dwordx4 v[80:83], v5, s[28:31], s47 offen sc1
    s_add_u32 s47, s48, 0
    buffer_load_dwordx4 v[84:87], v5, s[28:31], s47 offen sc1
    s_add_u32 s47, s46, 2048
    buffer_load_dwordx4 v[88:91], v5, s[28:31], s47 offen sc1
    s_add_u32 s47, s48, 2048
    buffer_load_dwordx4 v[92:95], v5, s[28:31], s47 offen sc1
    s_add_u32 s47, s46, 4096
    buffer_load_dwordx4 v[96:99], v5, s[28:31], s47 offen sc1
    s_add_u32 s47, s48, 4096
    buffer_load_dwordx4 v[100:103], v5, s[28:31], s47 offen sc1
    v_lshlrev_b32 v244, 16, v244
    v_lshlrev_b32 v9, 2, v0
    v_add_u32 v9, 147456, v9
    ds_write_b32 v9, v245
    ds_write_b32 v9, v244 offset:2048
    v_lshrrev_b32 v8, 2, v2
    v_and_b32 v9, 3, v1
    v_and_b32 v10, 1, v3
    v_xor_b32 v13, 0, v10
    v_lshl_add_u32 v12, v13, 2, v8
    v_lshl_add_u32 v12, v3, 3, v12
    v_lshlrev_b32 v12, 6, v12
    v_xor_b32 v13, v9, v13
    v_lshl_add_u32 v12, v13, 4, v12
    v_and_b32 v13, 1, v1
    v_lshl_add_u32 v12, v13, 3, v12
    v_xor_b32 v13, 8, v12
    v_xor_b32 v15, 1, v10
    v_lshl_add_u32 v14, v15, 2, v8
    v_lshl_add_u32 v14, v3, 3, v14
    v_lshlrev_b32 v14, 6, v14
    v_xor_b32 v15, v9, v15
    v_lshl_add_u32 v14, v15, 4, v14
    v_and_b32 v15, 1, v1
    v_lshl_add_u32 v14, v15, 3, v14
    v_xor_b32 v15, 8, v14
    s_lshl_b32 s41, s19, 11
    v_add_u32 v12, s41, v12
    v_add_u32 v16, 98304, v12
    v_add_u32 v12, 49152, v12
    v_add_u32 v13, s41, v13
    v_add_u32 v17, 98304, v13
    v_add_u32 v13, 49152, v13
    v_add_u32 v14, s41, v14
    v_add_u32 v18, 98304, v14
    v_add_u32 v14, 49152, v14
    v_add_u32 v15, s41, v15
    v_add_u32 v19, 98304, v15
    v_add_u32 v15, 49152, v15
    v_mov_b32 v21, 1.0
    v_mov_b32 v144, 0
    v_mov_b32 v145, 0
    v_mov_b32 v146, 0
    v_mov_b32 v147, 0
    v_mov_b32 v148, 0
    v_mov_b32 v149, 0
    v_mov_b32 v150, 0
    v_mov_b32 v151, 0
    v_mov_b32 v152, 0
    v_mov_b32 v153, 0
    v_mov_b32 v154, 0
    v_mov_b32 v155, 0
    v_mov_b32 v156, 0
    v_mov_b32 v157, 0
    v_mov_b32 v158, 0
    v_mov_b32 v159, 0
    v_mov_b32 v160, 0
    v_mov_b32 v161, 0
    v_mov_b32 v162, 0
    v_mov_b32 v163, 0
    v_mov_b32 v164, 0
    v_mov_b32 v165, 0
    v_mov_b32 v166, 0
    v_mov_b32 v167, 0
    v_mov_b32 v168, 0
    v_mov_b32 v169, 0
    v_mov_b32 v170, 0
    v_mov_b32 v171, 0
    v_mov_b32 v172, 0
    v_mov_b32 v173, 0
    v_mov_b32 v174, 0
    v_mov_b32 v175, 0
    v_mov_b32 v176, 0
    v_mov_b32 v177, 0
    v_mov_b32 v178, 0
    v_mov_b32 v179, 0
    v_mov_b32 v180, 0
    v_mov_b32 v181, 0
    v_mov_b32 v182, 0
    v_mov_b32 v183, 0
    v_mov_b32 v184, 0
    v_mov_b32 v185, 0
    v_mov_b32 v186, 0
    v_mov_b32 v187, 0
    v_mov_b32 v188, 0
    v_mov_b32 v189, 0
    v_mov_b32 v190, 0
    v_mov_b32 v191, 0
    s_mov_b32 s53, 0
    s_waitcnt vmcnt(20)
    s_waitcnt lgkmcnt(0)
    s_barrier
    ds_read_b64_tr_b16 v[192:193], v16 offset:0
    ds_read_b64_tr_b16 v[194:195], v18 offset:0
    ds_read_b64_tr_b16 v[196:197], v17 offset:0
    ds_read_b64_tr_b16 v[198:199], v19 offset:0
    ds_read_b64_tr_b16 v[200:201], v16 offset:16384
    ds_read_b64_tr_b16 v[202:203], v18 offset:16384
    ds_read_b64_tr_b16 v[204:205], v17 offset:16384
    ds_read_b64_tr_b16 v[206:207], v19 offset:16384
    ds_read_b64_tr_b16 v[208:209], v16 offset:32768
    ds_read_b64_tr_b16 v[210:211], v18 offset:32768
    ds_read_b64_tr_b16 v[212:213], v17 offset:32768
    ds_read_b64_tr_b16 v[214:215], v19 offset:32768
    s_waitcnt vmcnt(4)
P3A0_C:
    v_max3_u32 v10, v80, v81, v82
    v_max3_u32 v9, v83, v84, v85
    v_max3_u32 v10, v10, v86, v87
    v_max_u32 v10, v10, v9
    v_cmp_eq_u32 vcc, -1, v10
    s_cbranch_vccnz P3A0_R
P3A0_K:
    s_waitcnt lgkmcnt(10)
    v_mfma_f32_16x16x32_bf16 v[144:147], v[192:195], v[80:83], v[144:147]
    v_mfma_f32_16x16x32_bf16 v[168:171], v[192:195], v[84:87], v[168:171]
    ds_read_b64_tr_b16 v[216:217], v16 offset:4096
    ds_read_b64_tr_b16 v[218:219], v18 offset:4096
    s_add_u32 s47, s46, 6144
    buffer_load_dwordx4 v[104:107], v5, s[28:31], s47 offen sc1
    s_waitcnt lgkmcnt(10)
    v_mfma_f32_16x16x32_bf16 v[148:151], v[196:199], v[80:83], v[148:151]
    v_mfma_f32_16x16x32_bf16 v[172:175], v[196:199], v[84:87], v[172:175]
    ds_read_b64_tr_b16 v[220:221], v17 offset:4096
    ds_read_b64_tr_b16 v[222:223], v19 offset:4096
    s_add_u32 s47, s48, 6144
    buffer_load_dwordx4 v[108:111], v5, s[28:31], s47 offen sc1
    s_waitcnt lgkmcnt(10)
    v_mfma_f32_16x16x32_bf16 v[152:155], v[200:203], v[80:83], v[152:155]
    v_mfma_f32_16x16x32_bf16 v[176:179], v[200:203], v[84:87], v[176:179]
    ds_read_b64_tr_b16 v[224:225], v16 offset:20480
    ds_read_b64_tr_b16 v[226:227], v18 offset:20480
    s_add_u32 s47, s46, 8192
    buffer_load_dwordx4 v[112:115], v5, s[28:31], s47 offen sc1
    s_waitcnt lgkmcnt(10)
    v_mfma_f32_16x16x32_bf16 v[156:159], v[204:207], v[80:83], v[156:159]
    v_mfma_f32_16x16x32_bf16 v[180:183], v[204:207], v[84:87], v[180:183]
    ds_read_b64_tr_b16 v[228:229], v17 offset:20480
    ds_read_b64_tr_b16 v[230:231], v19 offset:20480
    s_add_u32 s47, s48, 8192
    buffer_load_dwordx4 v[116:119], v5, s[28:31], s47 offen sc1
    s_waitcnt lgkmcnt(10)
    v_mfma_f32_16x16x32_bf16 v[160:163], v[208:211], v[80:83], v[160:163]
    v_mfma_f32_16x16x32_bf16 v[184:187], v[208:211], v[84:87], v[184:187]
    ds_read_b64_tr_b16 v[232:233], v16 offset:36864
    ds_read_b64_tr_b16 v[234:235], v18 offset:36864
    s_waitcnt lgkmcnt(10)
    v_mfma_f32_16x16x32_bf16 v[164:167], v[212:215], v[80:83], v[164:167]
    v_mfma_f32_16x16x32_bf16 v[188:191], v[212:215], v[84:87], v[188:191]
    ds_read_b64_tr_b16 v[236:237], v17 offset:36864
    ds_read_b64_tr_b16 v[238:239], v19 offset:36864
    s_waitcnt vmcnt(6)
P3A1_C:
    v_max3_u32 v10, v88, v89, v90
    v_max3_u32 v9, v91, v92, v93
    v_max3_u32 v10, v10, v94, v95
    v_max_u32 v10, v10, v9
    v_cmp_eq_u32 vcc, -1, v10
    s_cbranch_vccnz P3A1_R
P3A1_K:
    s_waitcnt lgkmcnt(10)
    v_mfma_f32_16x16x32_bf16 v[144:147], v[216:219], v[88:91], v[144:147]
    v_mfma_f32_16x16x32_bf16 v[168:171], v[216:219], v[92:95], v[168:171]
    ds_read_b64_tr_b16 v[192:193], v16 offset:8192
    ds_read_b64_tr_b16 v[194:195], v18 offset:8192
    s_add_u32 s47, s46, 10240
    buffer_load_dwordx4 v[120:123], v5, s[28:31], s47 offen sc1
    s_waitcnt lgkmcnt(10)
    v_mfma_f32_16x16x32_bf16 v[148:151], v[220:223], v[88:91], v[148:151]
    v_mfma_f32_16x16x32_bf16 v[172:175], v[220:223], v[92:95], v[172:175]
    ds_read_b64_tr_b16 v[196:197], v17 offset:8192
    ds_read_b64_tr_b16 v[198:199], v19 offset:8192
    s_add_u32 s47, s48, 10240
    buffer_load_dwordx4 v[124:127], v5, s[28:31], s47 offen sc1
    s_waitcnt lgkmcnt(10)
    v_mfma_f32_16x16x32_bf16 v[152:155], v[224:227], v[88:91], v[152:155]
    v_mfma_f32_16x16x32_bf16 v[176:179], v[224:227], v[92:95], v[176:179]
    ds_read_b64_tr_b16 v[200:201], v16 offset:24576
    ds_read_b64_tr_b16 v[202:203], v18 offset:24576
    s_add_u32 s47, s46, 12288
    buffer_load_dwordx4 v[128:131], v5, s[28:31], s47 offen sc1
    s_waitcnt lgkmcnt(10)
    v_mfma_f32_16x16x32_bf16 v[156:159], v[228:231], v[88:91], v[156:159]
    v_mfma_f32_16x16x32_bf16 v[180:183], v[228:231], v[92:95], v[180:183]
    ds_read_b64_tr_b16 v[204:205], v17 offset:24576
    ds_read_b64_tr_b16 v[206:207], v19 offset:24576
    s_add_u32 s47, s48, 12288
    buffer_load_dwordx4 v[132:135], v5, s[28:31], s47 offen sc1
    s_waitcnt lgkmcnt(10)
    v_mfma_f32_16x16x32_bf16 v[160:163], v[232:235], v[88:91], v[160:163]
    v_mfma_f32_16x16x32_bf16 v[184:187], v[232:235], v[92:95], v[184:187]
    ds_read_b64_tr_b16 v[208:209], v16 offset:40960
    ds_read_b64_tr_b16 v[210:211], v18 offset:40960
    s_waitcnt lgkmcnt(10)
    v_mfma_f32_16x16x32_bf16 v[164:167], v[236:239], v[88:91], v[164:167]
    v_mfma_f32_16x16x32_bf16 v[188:191], v[236:239], v[92:95], v[188:191]
    ds_read_b64_tr_b16 v[212:213], v17 offset:40960
    ds_read_b64_tr_b16 v[214:215], v19 offset:40960
    s_waitcnt vmcnt(8)
P3A2_C:
    v_max3_u32 v10, v96, v97, v98
    v_max3_u32 v9, v99, v100, v101
    v_max3_u32 v10, v10, v102, v103
    v_max_u32 v10, v10, v9
    v_cmp_eq_u32 vcc, -1, v10
    s_cbranch_vccnz P3A2_R
P3A2_K:
    s_waitcnt lgkmcnt(10)
    v_mfma_f32_16x16x32_bf16 v[144:147], v[192:195], v[96:99], v[144:147]
    v_mfma_f32_16x16x32_bf16 v[168:171], v[192:195], v[100:103], v[168:171]
    ds_read_b64_tr_b16 v[216:217], v16 offset:12288
    ds_read_b64_tr_b16 v[218:219], v18 offset:12288
    s_add_u32 s47, s46, 14336
    buffer_load_dwordx4 v[136:139], v5, s[28:31], s47 offen sc1
    s_waitcnt lgkmcnt(10)
    v_mfma_f32_16x16x32_bf16 v[148:151], v[196:199], v[96:99], v[148:151]
    v_mfma_f32_16x16x32_bf16 v[172:175], v[196:199], v[100:103], v[172:175]
    ds_read_b64_tr_b16 v[220:221], v17 offset:12288
    ds_read_b64_tr_b16 v[222:223], v19 offset:12288
    s_add_u32 s47, s48, 14336
    buffer_load_dwordx4 v[140:143], v5, s[28:31], s47 offen sc1
    s_waitcnt lgkmcnt(10)
    v_mfma_f32_16x16x32_bf16 v[152:155], v[200:203], v[96:99], v[152:155]
    v_mfma_f32_16x16x32_bf16 v[176:179], v[200:203], v[100:103], v[176:179]
    ds_read_b64_tr_b16 v[224:225], v16 offset:28672
    ds_read_b64_tr_b16 v[226:227], v18 offset:28672
    s_waitcnt lgkmcnt(10)
    v_mfma_f32_16x16x32_bf16 v[156:159], v[204:207], v[96:99], v[156:159]
    v_mfma_f32_16x16x32_bf16 v[180:183], v[204:207], v[100:103], v[180:183]
    ds_read_b64_tr_b16 v[228:229], v17 offset:28672
    ds_read_b64_tr_b16 v[230:231], v19 offset:28672
    s_waitcnt lgkmcnt(10)
    v_mfma_f32_16x16x32_bf16 v[160:163], v[208:211], v[96:99], v[160:163]
    v_mfma_f32_16x16x32_bf16 v[184:187], v[208:211], v[100:103], v[184:187]
    ds_read_b64_tr_b16 v[232:233], v16 offset:45056
    ds_read_b64_tr_b16 v[234:235], v18 offset:45056
    s_waitcnt lgkmcnt(10)
    v_mfma_f32_16x16x32_bf16 v[164:167], v[212:215], v[96:99], v[164:167]
    v_mfma_f32_16x16x32_bf16 v[188:191], v[212:215], v[100:103], v[188:191]
    ds_read_b64_tr_b16 v[236:237], v17 offset:45056
    ds_read_b64_tr_b16 v[238:239], v19 offset:45056
    s_waitcnt vmcnt(8)
P3A3_C:
    v_max3_u32 v10, v104, v105, v106
    v_max3_u32 v9, v107, v108, v109
    v_max3_u32 v10, v10, v110, v111
    v_max_u32 v10, v10, v9
    v_cmp_eq_u32 vcc, -1, v10
    s_cbranch_vccnz P3A3_R
P3A3_K:
    s_barrier
    s_waitcnt lgkmcnt(10)
    v_mfma_f32_16x16x32_bf16 v[144:147], v[216:219], v[104:107], v[144:147]
    v_mfma_f32_16x16x32_bf16 v[168:171], v[216:219], v[108:111], v[168:171]
    ds_read_b64_tr_b16 v[192:193], v12 offset:0
    ds_read_b64_tr_b16 v[194:195], v14 offset:0
    s_waitcnt lgkmcnt(10)
    v_mfma_f32_16x16x32_bf16 v[148:151], v[220:223], v[104:107], v[148:151]
    v_mfma_f32_16x16x32_bf16 v[172:175], v[220:223], v[108:111], v[172:175]
    ds_read_b64_tr_b16 v[196:197], v13 offset:0
    ds_read_b64_tr_b16 v[198:199], v15 offset:0
    s_waitcnt lgkmcnt(10)
    v_mfma_f32_16x16x32_bf16 v[152:155], v[224:227], v[104:107], v[152:155]
    v_mfma_f32_16x16x32_bf16 v[176:179], v[224:227], v[108:111], v[176:179]
    ds_read_b64_tr_b16 v[200:201], v12 offset:16384
    ds_read_b64_tr_b16 v[202:203], v14 offset:16384
    s_waitcnt lgkmcnt(10)
    v_mfma_f32_16x16x32_bf16 v[156:159], v[228:231], v[104:107], v[156:159]
    v_mfma_f32_16x16x32_bf16 v[180:183], v[228:231], v[108:111], v[180:183]
    ds_read_b64_tr_b16 v[204:205], v13 offset:16384
    ds_read_b64_tr_b16 v[206:207], v15 offset:16384
    s_waitcnt lgkmcnt(10)
    v_mfma_f32_16x16x32_bf16 v[160:163], v[232:235], v[104:107], v[160:163]
    v_mfma_f32_16x16x32_bf16 v[184:187], v[232:235], v[108:111], v[184:187]
    ds_read_b64_tr_b16 v[208:209], v12 offset:32768
    ds_read_b64_tr_b16 v[210:211], v14 offset:32768
    s_waitcnt lgkmcnt(10)
    v_mfma_f32_16x16x32_bf16 v[164:167], v[236:239], v[104:107], v[164:167]
    v_mfma_f32_16x16x32_bf16 v[188:191], v[236:239], v[108:111], v[188:191]
    ds_read_b64_tr_b16 v[212:213], v13 offset:32768
    ds_read_b64_tr_b16 v[214:215], v15 offset:32768
    s_lshl_b32 s44, s16, 11
    s_add_u32 s44, s44, 9895936
    buffer_load_dwordx4 v[72:75], v5, s[28:31], s44 offen sc1
    buffer_load_dwordx4 v[76:79], v5, s[28:31], s44 offen offset:1024 sc1
    s_waitcnt vmcnt(8)
P3A4_C:
    v_max3_u32 v10, v112, v113, v114
    v_max3_u32 v9, v115, v116, v117
    v_max3_u32 v10, v10, v118, v119
    v_max_u32 v10, v10, v9
    v_cmp_eq_u32 vcc, -1, v10
    s_cbranch_vccnz P3A4_R
P3A4_K:
    s_waitcnt lgkmcnt(10)
    v_mfma_f32_16x16x32_bf16 v[144:147], v[192:195], v[112:115], v[144:147]
    v_mfma_f32_16x16x32_bf16 v[168:171], v[192:195], v[116:119], v[168:171]
    ds_read_b64_tr_b16 v[216:217], v12 offset:4096
    ds_read_b64_tr_b16 v[218:219], v14 offset:4096
    s_waitcnt lgkmcnt(10)
    v_mfma_f32_16x16x32_bf16 v[148:151], v[196:199], v[112:115], v[148:151]
    v_mfma_f32_16x16x32_bf16 v[172:175], v[196:199], v[116:119], v[172:175]
    ds_read_b64_tr_b16 v[220:221], v13 offset:4096
    ds_read_b64_tr_b16 v[222:223], v15 offset:4096
    s_waitcnt lgkmcnt(10)
    v_mfma_f32_16x16x32_bf16 v[152:155], v[200:203], v[112:115], v[152:155]
    v_mfma_f32_16x16x32_bf16 v[176:179], v[200:203], v[116:119], v[176:179]
    ds_read_b64_tr_b16 v[224:225], v12 offset:20480
    ds_read_b64_tr_b16 v[226:227], v14 offset:20480
    s_waitcnt lgkmcnt(10)
    v_mfma_f32_16x16x32_bf16 v[156:159], v[204:207], v[112:115], v[156:159]
    v_mfma_f32_16x16x32_bf16 v[180:183], v[204:207], v[116:119], v[180:183]
    ds_read_b64_tr_b16 v[228:229], v13 offset:20480
    ds_read_b64_tr_b16 v[230:231], v15 offset:20480
    s_waitcnt lgkmcnt(10)
    v_mfma_f32_16x16x32_bf16 v[160:163], v[208:211], v[112:115], v[160:163]
    v_mfma_f32_16x16x32_bf16 v[184:187], v[208:211], v[116:119], v[184:187]
    ds_read_b64_tr_b16 v[232:233], v12 offset:36864
    ds_read_b64_tr_b16 v[234:235], v14 offset:36864
    s_waitcnt lgkmcnt(10)
    v_mfma_f32_16x16x32_bf16 v[164:167], v[212:215], v[112:115], v[164:167]
    v_mfma_f32_16x16x32_bf16 v[188:191], v[212:215], v[116:119], v[188:191]
    ds_read_b64_tr_b16 v[236:237], v13 offset:36864
    ds_read_b64_tr_b16 v[238:239], v15 offset:36864
    s_waitcnt vmcnt(6)
P3A5_C:
    v_max3_u32 v10, v120, v121, v122
    v_max3_u32 v9, v123, v124, v125
    v_max3_u32 v10, v10, v126, v127
    v_max_u32 v10, v10, v9
    v_cmp_eq_u32 vcc, -1, v10
    s_cbranch_vccnz P3A5_R
P3A5_K:
    s_waitcnt lgkmcnt(10)
    v_mfma_f32_16x16x32_bf16 v[144:147], v[216:219], v[120:123], v[144:147]
    v_mfma_f32_16x16x32_bf16 v[168:171], v[216:219], v[124:127], v[168:171]
    ds_read_b64_tr_b16 v[192:193], v12 offset:8192
    ds_read_b64_tr_b16 v[194:195], v14 offset:8192
    s_waitcnt lgkmcnt(10)
    v_mfma_f32_16x16x32_bf16 v[148:151], v[220:223], v[120:123], v[148:151]
    v_mfma_f32_16x16x32_bf16 v[172:175], v[220:223], v[124:127], v[172:175]
    ds_read_b64_tr_b16 v[196:197], v13 offset:8192
    ds_read_b64_tr_b16 v[198:199], v15 offset:8192
    s_waitcnt lgkmcnt(10)
    v_mfma_f32_16x16x32_bf16 v[152:155], v[224:227], v[120:123], v[152:155]
    v_mfma_f32_16x16x32_bf16 v[176:179], v[224:227], v[124:127], v[176:179]
    ds_read_b64_tr_b16 v[200:201], v12 offset:24576
    ds_read_b64_tr_b16 v[202:203], v14 offset:24576
    s_waitcnt lgkmcnt(10)
    v_mfma_f32_16x16x32_bf16 v[156:159], v[228:231], v[120:123], v[156:159]
    v_mfma_f32_16x16x32_bf16 v[180:183], v[228:231], v[124:127], v[180:183]
    ds_read_b64_tr_b16 v[204:205], v13 offset:24576
    ds_read_b64_tr_b16 v[206:207], v15 offset:24576
    s_waitcnt lgkmcnt(10)
    v_mfma_f32_16x16x32_bf16 v[160:163], v[232:235], v[120:123], v[160:163]
    v_mfma_f32_16x16x32_bf16 v[184:187], v[232:235], v[124:127], v[184:187]
    ds_read_b64_tr_b16 v[208:209], v12 offset:40960
    ds_read_b64_tr_b16 v[210:211], v14 offset:40960
    s_waitcnt lgkmcnt(10)
    v_mfma_f32_16x16x32_bf16 v[164:167], v[236:239], v[120:123], v[164:167]
    v_mfma_f32_16x16x32_bf16 v[188:191], v[236:239], v[124:127], v[188:191]
    ds_read_b64_tr_b16 v[212:213], v13 offset:40960
    ds_read_b64_tr_b16 v[214:215], v15 offset:40960
    s_waitcnt vmcnt(4)
P3A6_C:
    v_max3_u32 v10, v128, v129, v130
    v_max3_u32 v9, v131, v132, v133
    v_max3_u32 v10, v10, v134, v135
    v_max_u32 v10, v10, v9
    v_cmp_eq_u32 vcc, -1, v10
    s_cbranch_vccnz P3A6_R
P3A6_K:
    s_waitcnt lgkmcnt(10)
    v_mfma_f32_16x16x32_bf16 v[144:147], v[192:195], v[128:131], v[144:147]
    v_mfma_f32_16x16x32_bf16 v[168:171], v[192:195], v[132:135], v[168:171]
    ds_read_b64_tr_b16 v[216:217], v12 offset:12288
    ds_read_b64_tr_b16 v[218:219], v14 offset:12288
    s_waitcnt lgkmcnt(10)
    v_mfma_f32_16x16x32_bf16 v[148:151], v[196:199], v[128:131], v[148:151]
    v_mfma_f32_16x16x32_bf16 v[172:175], v[196:199], v[132:135], v[172:175]
    ds_read_b64_tr_b16 v[220:221], v13 offset:12288
    ds_read_b64_tr_b16 v[222:223], v15 offset:12288
    s_waitcnt lgkmcnt(10)
    v_mfma_f32_16x16x32_bf16 v[152:155], v[200:203], v[128:131], v[152:155]
    v_mfma_f32_16x16x32_bf16 v[176:179], v[200:203], v[132:135], v[176:179]
    ds_read_b64_tr_b16 v[224:225], v12 offset:28672
    ds_read_b64_tr_b16 v[226:227], v14 offset:28672
    s_waitcnt lgkmcnt(10)
    v_mfma_f32_16x16x32_bf16 v[156:159], v[204:207], v[128:131], v[156:159]
    v_mfma_f32_16x16x32_bf16 v[180:183], v[204:207], v[132:135], v[180:183]
    ds_read_b64_tr_b16 v[228:229], v13 offset:28672
    ds_read_b64_tr_b16 v[230:231], v15 offset:28672
    s_waitcnt lgkmcnt(10)
    v_mfma_f32_16x16x32_bf16 v[160:163], v[208:211], v[128:131], v[160:163]
    v_mfma_f32_16x16x32_bf16 v[184:187], v[208:211], v[132:135], v[184:187]
    ds_read_b64_tr_b16 v[232:233], v12 offset:45056
    ds_read_b64_tr_b16 v[234:235], v14 offset:45056
    s_waitcnt lgkmcnt(10)
    v_mfma_f32_16x16x32_bf16 v[164:167], v[212:215], v[128:131], v[164:167]
    v_mfma_f32_16x16x32_bf16 v[188:191], v[212:215], v[132:135], v[188:191]
    ds_read_b64_tr_b16 v[236:237], v13 offset:45056
    ds_read_b64_tr_b16 v[238:239], v15 offset:45056
    s_waitcnt vmcnt(2)
P3A7_C:
    v_max3_u32 v10, v136, v137, v138
    v_max3_u32 v9, v139, v140, v141
    v_max3_u32 v10, v10, v142, v143
    v_max_u32 v10, v10, v9
    v_cmp_eq_u32 vcc, -1, v10
    s_cbranch_vccnz P3A7_R
P3A7_K:
    s_waitcnt lgkmcnt(10)
    v_mfma_f32_16x16x32_bf16 v[144:147], v[216:219], v[136:139], v[144:147]
    v_mfma_f32_16x16x32_bf16 v[168:171], v[216:219], v[140:143], v[168:171]
    s_waitcnt lgkmcnt(8)
    v_mfma_f32_16x16x32_bf16 v[148:151], v[220:223], v[136:139], v[148:151]
    v_mfma_f32_16x16x32_bf16 v[172:175], v[220:223], v[140:143], v[172:175]
    s_waitcnt lgkmcnt(6)
    v_mfma_f32_16x16x32_bf16 v[152:155], v[224:227], v[136:139], v[152:155]
    v_mfma_f32_16x16x32_bf16 v[176:179], v[224:227], v[140:143], v[176:179]
    s_waitcnt lgkmcnt(4)
    v_mfma_f32_16x16x32_bf16 v[156:159], v[228:231], v[136:139], v[156:159]
    v_mfma_f32_16x16x32_bf16 v[180:183], v[228:231], v[140:143], v[180:183]
    s_waitcnt lgkmcnt(2)
    v_mfma_f32_16x16x32_bf16 v[160:163], v[232:235], v[136:139], v[160:163]
    v_mfma_f32_16x16x32_bf16 v[184:187], v[232:235], v[140:143], v[184:187]
    s_waitcnt lgkmcnt(0)
    v_mfma_f32_16x16x32_bf16 v[164:167], v[236:239], v[136:139], v[164:167]
    v_mfma_f32_16x16x32_bf16 v[188:191], v[236:239], v[140:143], v[188:191]
    s_mul_i32 s40, s18, 12288
    s_xor_b32 s41, s19, 1
    s_mul_i32 s41, s41, 6144
    s_add_u32 s41, s41, s40
    v_add_u32 v8, s41, v5
    s_cmp_eq_u32 s19, 0
    s_nop 1
    s_cbranch_scc0 KF3_R1
    ds_write_b128 v8, v[168:171] offset:0
    ds_write_b128 v8, v[172:175] offset:1024
    ds_write_b128 v8, v[176:179] offset:2048
    ds_write_b128 v8, v[180:183] offset:3072
    ds_write_b128 v8, v[184:187] offset:4096
    ds_write_b128 v8, v[188:191] offset:5120
    s_branch KF3_R2
KF3_R1:
    ds_write_b128 v8, v[144:147] offset:0
    ds_write_b128 v8, v[148:151] offset:1024
    ds_write_b128 v8, v[152:155] offset:2048
    ds_write_b128 v8, v[156:159] offset:3072
    ds_write_b128 v8, v[160:163] offset:4096
    ds_write_b128 v8, v[164:167] offset:5120
    v_pk_mov_b32 v[144:145], v[168:169], v[168:169] op_sel:[0,1]
    v_pk_mov_b32 v[146:147], v[170:171], v[170:171] op_sel:[0,1]
    v_pk_mov_b32 v[148:149], v[172:173], v[172:173] op_sel:[0,1]
    v_pk_mov_b32 v[150:151], v[174:175], v[174:175] op_sel:[0,1]
    v_pk_mov_b32 v[152:153], v[176:177], v[176:177] op_sel:[0,1]
    v_pk_mov_b32 v[154:155], v[178:179], v[178:179] op_sel:[0,1]
    v_pk_mov_b32 v[156:157], v[180:181], v[180:181] op_sel:[0,1]
    v_pk_mov_b32 v[158:159], v[182:183], v[182:183] op_sel:[0,1]
    v_pk_mov_b32 v[160:161], v[184:185], v[184:185] op_sel:[0,1]
    v_pk_mov_b32 v[162:163], v[186:187], v[186:187] op_sel:[0,1]
    v_pk_mov_b32 v[164:165], v[188:189], v[188:189] op_sel:[0,1]
    v_pk_mov_b32 v[166:167], v[190:191], v[190:191] op_sel:[0,1]
    s_nop 2
KF3_R2:
    s_waitcnt vmcnt(0)
P3S_C:
    v_max3_u32 v10, v72, v73, v74
    v_max3_u32 v9, v75, v76, v77
    v_max3_u32 v10, v10, v78, v79
    v_max_u32 v10, v10, v9
    v_cmp_eq_u32 vcc, -1, v10
    s_cbranch_vccnz P3S_R
P3S_K:
    v_pk_add_f32 v[72:73], v[72:73], v[74:75]
    v_pk_add_f32 v[76:77], v[76:77], v[78:79]
    v_pk_add_f32 v[72:73], v[72:73], v[76:77]
    s_nop 1
    v_mfma_f32_16x16x4_f32 v[192:195], v21, v72, 0
    v_mfma_f32_16x16x4_f32 v[196:199], v21, v73, 0
    s_mov_b32 s20, s72
    s_and_b32 s21, s73, 0xffff
    s_mov_b32 s22, 1409024
    s_mov_b32 s23, 0x20000
    s_waitcnt lgkmcnt(0)
    s_barrier
    s_mul_i32 s41, s19, 6144
    s_add_u32 s41, s41, s40
    v_add_u32 v8, s41, v5
    v_and_b32 v9, 1, v3
    v_lshlrev_b32 v9, 4, v9
    v_lshl_add_u32 v9, v3, 5, v9
    v_add_u32 v9, 147456, v9
    v_xor_b32 v10, 16, v9
    ds_read_b128 v[80:83], v8 offset:0
    ds_read_b128 v[48:51], v9 offset:0
    ds_read_b128 v[24:27], v9 offset:2048
    ds_read_b128 v[84:87], v8 offset:1024
    ds_read_b128 v[52:55], v10 offset:0
    ds_read_b128 v[28:31], v10 offset:2048
    ds_read_b128 v[88:91], v8 offset:2048
    ds_read_b128 v[56:59], v9 offset:128
    ds_read_b128 v[32:35], v9 offset:2176
    ds_read_b128 v[92:95], v8 offset:3072
    ds_read_b128 v[60:63], v10 offset:128
    ds_read_b128 v[36:39], v10 offset:2176
    s_mov_b32 s42, 0x3b000000
    s_mov_b32 s43, 0x3727c5ac
    v_mul_f32 v192, s42, v192
    v_mul_f32 v196, s42, v196
    v_fma_f32 v196, -v192, v192, v196
    v_max_f32 v196, 0, v196
    v_add_f32 v196, s43, v196
    v_rsq_f32 v196, v196
    ds_read_b128 v[96:99], v8 offset:4096
    ds_read_b128 v[64:67], v9 offset:256
    ds_read_b128 v[40:43], v9 offset:2304
    ds_read_b128 v[100:103], v8 offset:5120
    ds_read_b128 v[68:71], v10 offset:256
    ds_read_b128 v[44:47], v10 offset:2304
    s_mov_b32 s42, 0x3fb8aa3b
    s_mov_b32 s43, 0x3fb8aa3b
    s_mov_b32 s56, 2.0
    s_mov_b32 s57, 2.0
    s_mov_b32 s48, 0x41e6d4ca
    s_mul_i32 s40, s16, 43
    s_add_u32 s40, s40, s77
    s_lshl_b32 s40, s40, 10
    s_add_u32 s40, s40, 4259840
    s_lshl_b32 s54, s12, 13
    s_lshl_b32 s44, s14, 7
    s_add_u32 s54, s54, s44
    s_lshl_b32 s55, s12, 10
    s_add_u32 m0, s55, 49152
    s_add_u32 s45, s54, 0
    buffer_load_dwordx4 v7, s[20:23], s45 offen lds
    s_add_u32 m0, s55, 57344
    s_add_u32 s45, s54, 65536
    buffer_load_dwordx4 v7, s[20:23], s45 offen lds
    s_waitcnt lgkmcnt(15)
    v_pk_add_f32 v[144:145], v[144:145], v[80:81]
    v_pk_fma_f32 v[144:145], v[48:49], v[192:193], v[144:145] op_sel_hi:[1,0,1] neg_lo:[0,1,0] neg_hi:[0,1,0]
    v_pk_fma_f32 v[144:145], v[144:145], v[196:197], v[24:25] op_sel_hi:[1,0,1]
    v_pk_mul_f32 v[200:201], v[144:145], s[42:43]
    v_min_f32 v200, s48, v200
    v_min_f32 v201, s48, v201
    v_pk_add_f32 v[146:147], v[146:147], v[82:83]
    v_pk_fma_f32 v[146:147], v[50:51], v[192:193], v[146:147] op_sel_hi:[1,0,1] neg_lo:[0,1,0] neg_hi:[0,1,0]
    v_pk_fma_f32 v[146:147], v[146:147], v[196:197], v[26:27] op_sel_hi:[1,0,1]
    v_pk_mul_f32 v[204:205], v[146:147], s[42:43]
    v_min_f32 v204, s48, v204
    v_min_f32 v205, s48, v205
    v_exp_f32 v200, v200
    v_exp_f32 v201, v201
    v_exp_f32 v204, v204
    v_exp_f32 v205, v205
    v_pk_add_f32 v[202:203], v[200:201], s[56:57]
    v_pk_mul_f32 v[200:201], v[200:201], v[202:203]
    v_pk_add_f32 v[202:203], v[200:201], s[56:57]
    v_pk_add_f32 v[206:207], v[204:205], s[56:57]
    v_pk_mul_f32 v[204:205], v[204:205], v[206:207]
    v_pk_add_f32 v[206:207], v[204:205], s[56:57]
    v_rcp_f32 v202, v202
    v_rcp_f32 v203, v203
    v_rcp_f32 v206, v206
    v_rcp_f32 v207, v207
    v_pk_mul_f32 v[200:201], v[200:201], v[144:145]
    v_pk_mul_f32 v[144:145], v[200:201], v[202:203]
    v_cvt_pk_bf16_f32 v112, v144, v145
    v_pk_mul_f32 v[204:205], v[204:205], v[146:147]
    v_pk_mul_f32 v[146:147], v[204:205], v[206:207]
    v_cvt_pk_bf16_f32 v113, v146, v147
    s_add_u32 m0, s55, 65536
    s_add_u32 s45, s54, 131072
    buffer_load_dwordx4 v7, s[20:23], s45 offen lds
    s_add_u32 m0, s55, 73728
    s_add_u32 s45, s54, 196608
    buffer_load_dwordx4 v7, s[20:23], s45 offen lds
    s_waitcnt lgkmcnt(12)
    v_pk_add_f32 v[148:149], v[148:149], v[84:85]
    v_pk_fma_f32 v[148:149], v[52:53], v[192:193], v[148:149] op_sel_hi:[1,0,1] neg_lo:[0,1,0] neg_hi:[0,1,0]
    v_pk_fma_f32 v[148:149], v[148:149], v[196:197], v[28:29] op_sel_hi:[1,0,1]
    v_pk_mul_f32 v[200:201], v[148:149], s[42:43]
    v_min_f32 v200, s48, v200
    v_min_f32 v201, s48, v201
    v_pk_add_f32 v[150:151], v[150:151], v[86:87]
    v_pk_fma_f32 v[150:151], v[54:55], v[192:193], v[150:151] op_sel_hi:[1,0,1] neg_lo:[0,1,0] neg_hi:[0,1,0]
    v_pk_fma_f32 v[150:151], v[150:151], v[196:197], v[30:31] op_sel_hi:[1,0,1]
    v_pk_mul_f32 v[204:205], v[150:151], s[42:43]
    v_min_f32 v204, s48, v204
    v_min_f32 v205, s48, v205
    v_exp_f32 v200, v200
    v_exp_f32 v201, v201
    v_exp_f32 v204, v204
    v_exp_f32 v205, v205
    v_pk_add_f32 v[202:203], v[200:201], s[56:57]
    v_pk_mul_f32 v[200:201], v[200:201], v[202:203]
    v_pk_add_f32 v[202:203], v[200:201], s[56:57]
    v_pk_add_f32 v[206:207], v[204:205], s[56:57]
    v_pk_mul_f32 v[204:205], v[204:205], v[206:207]
    v_pk_add_f32 v[206:207], v[204:205], s[56:57]
    v_rcp_f32 v202, v202
    v_rcp_f32 v203, v203
    v_rcp_f32 v206, v206
    v_rcp_f32 v207, v207
    v_pk_mul_f32 v[200:201], v[200:201], v[148:149]
    v_pk_mul_f32 v[148:149], v[200:201], v[202:203]
    v_cvt_pk_bf16_f32 v114, v148, v149
    v_pk_mul_f32 v[204:205], v[204:205], v[150:151]
    v_pk_mul_f32 v[150:151], v[204:205], v[206:207]
    v_cvt_pk_bf16_f32 v115, v150, v151
    buffer_store_dwordx4 v[112:115], v5, s[28:31], s40 offen offset:0 sc1
    s_add_u32 m0, s55, 81920
    s_add_u32 s45, s54, 262144
    buffer_load_dwordx4 v7, s[20:23], s45 offen lds
    s_add_u32 m0, s55, 90112
    s_add_u32 s45, s54, 327680
    buffer_load_dwordx4 v7, s[20:23], s45 offen lds
    s_waitcnt lgkmcnt(9)
    v_pk_add_f32 v[152:153], v[152:153], v[88:89]
    v_pk_fma_f32 v[152:153], v[56:57], v[192:193], v[152:153] op_sel_hi:[1,0,1] neg_lo:[0,1,0] neg_hi:[0,1,0]
    v_pk_fma_f32 v[152:153], v[152:153], v[196:197], v[32:33] op_sel_hi:[1,0,1]
    v_pk_mul_f32 v[200:201], v[152:153], s[42:43]
    v_min_f32 v200, s48, v200
    v_min_f32 v201, s48, v201
    v_pk_add_f32 v[154:155], v[154:155], v[90:91]
    v_pk_fma_f32 v[154:155], v[58:59], v[192:193], v[154:155] op_sel_hi:[1,0,1] neg_lo:[0,1,0] neg_hi:[0,1,0]
    v_pk_fma_f32 v[154:155], v[154:155], v[196:197], v[34:35] op_sel_hi:[1,0,1]
    v_pk_mul_f32 v[204:205], v[154:155], s[42:43]
    v_min_f32 v204, s48, v204
    v_min_f32 v205, s48, v205
    v_exp_f32 v200, v200
    v_exp_f32 v201, v201
    v_exp_f32 v204, v204
    v_exp_f32 v205, v205
    v_pk_add_f32 v[202:203], v[200:201], s[56:57]
    v_pk_mul_f32 v[200:201], v[200:201], v[202:203]
    v_pk_add_f32 v[202:203], v[200:201], s[56:57]
    v_pk_add_f32 v[206:207], v[204:205], s[56:57]
    v_pk_mul_f32 v[204:205], v[204:205], v[206:207]
    v_pk_add_f32 v[206:207], v[204:205], s[56:57]
    v_rcp_f32 v202, v202
    v_rcp_f32 v203, v203
    v_rcp_f32 v206, v206
    v_rcp_f32 v207, v207
    v_pk_mul_f32 v[200:201], v[200:201], v[152:153]
    v_pk_mul_f32 v[152:153], v[200:201], v[202:203]
    v_cvt_pk_bf16_f32 v116, v152, v153
    v_pk_mul_f32 v[204:205], v[204:205], v[154:155]
    v_pk_mul_f32 v[154:155], v[204:205], v[206:207]
    v_cvt_pk_bf16_f32 v117, v154, v155
    s_add_u32 m0, s55, 98304
    s_add_u32 s45, s54, 393216
    buffer_load_dwordx4 v7, s[20:23], s45 offen lds
    s_add_u32 m0, s55, 106496
    s_add_u32 s45, s54, 458752
    buffer_load_dwordx4 v7, s[20:23], s45 offen lds
    s_waitcnt lgkmcnt(6)
    v_pk_add_f32 v[156:157], v[156:157], v[92:93]
    v_pk_fma_f32 v[156:157], v[60:61], v[192:193], v[156:157] op_sel_hi:[1,0,1] neg_lo:[0,1,0] neg_hi:[0,1,0]
    v_pk_fma_f32 v[156:157], v[156:157], v[196:197], v[36:37] op_sel_hi:[1,0,1]
    v_pk_mul_f32 v[200:201], v[156:157], s[42:43]
    v_min_f32 v200, s48, v200
    v_min_f32 v201, s48, v201
    v_pk_add_f32 v[158:159], v[158:159], v[94:95]
    v_pk_fma_f32 v[158:159], v[62:63], v[192:193], v[158:159] op_sel_hi:[1,0,1] neg_lo:[0,1,0] neg_hi:[0,1,0]
    v_pk_fma_f32 v[158:159], v[158:159], v[196:197], v[38:39] op_sel_hi:[1,0,1]
    v_pk_mul_f32 v[204:205], v[158:159], s[42:43]
    v_min_f32 v204, s48, v204
    v_min_f32 v205, s48, v205
    v_exp_f32 v200, v200
    v_exp_f32 v201, v201
    v_exp_f32 v204, v204
    v_exp_f32 v205, v205
    v_pk_add_f32 v[202:203], v[200:201], s[56:57]
    v_pk_mul_f32 v[200:201], v[200:201], v[202:203]
    v_pk_add_f32 v[202:203], v[200:201], s[56:57]
    v_pk_add_f32 v[206:207], v[204:205], s[56:57]
    v_pk_mul_f32 v[204:205], v[204:205], v[206:207]
    v_pk_add_f32 v[206:207], v[204:205], s[56:57]
    v_rcp_f32 v202, v202
    v_rcp_f32 v203, v203
    v_rcp_f32 v206, v206
    v_rcp_f32 v207, v207
    v_pk_mul_f32 v[200:201], v[200:201], v[156:157]
    v_pk_mul_f32 v[156:157], v[200:201], v[202:203]
    v_cvt_pk_bf16_f32 v118, v156, v157
    v_pk_mul_f32 v[204:205], v[204:205], v[158:159]
    v_pk_mul_f32 v[158:159], v[204:205], v[206:207]
    v_cvt_pk_bf16_f32 v119, v158, v159
    buffer_store_dwordx4 v[116:119], v5, s[28:31], s40 offen offset:1024 sc1
    s_add_u32 m0, s55, 114688
    s_add_u32 s45, s54, 524288
    buffer_load_dwordx4 v7, s[20:23], s45 offen lds
    s_add_u32 m0, s55, 122880
    s_add_u32 s45, s54, 589824
    buffer_load_dwordx4 v7, s[20:23], s45 offen lds
    s_waitcnt lgkmcnt(3)
    v_pk_add_f32 v[160:161], v[160:161], v[96:97]
    v_pk_fma_f32 v[160:161], v[64:65], v[192:193], v[160:161] op_sel_hi:[1,0,1] neg_lo:[0,1,0] neg_hi:[0,1,0]
    v_pk_fma_f32 v[160:161], v[160:161], v[196:197], v[40:41] op_sel_hi:[1,0,1]
    v_pk_mul_f32 v[200:201], v[160:161], s[42:43]
    v_min_f32 v200, s48, v200
    v_min_f32 v201, s48, v201
    v_pk_add_f32 v[162:163], v[162:163], v[98:99]
    v_pk_fma_f32 v[162:163], v[66:67], v[192:193], v[162:163] op_sel_hi:[1,0,1] neg_lo:[0,1,0] neg_hi:[0,1,0]
    v_pk_fma_f32 v[162:163], v[162:163], v[196:197], v[42:43] op_sel_hi:[1,0,1]
    v_pk_mul_f32 v[204:205], v[162:163], s[42:43]
    v_min_f32 v204, s48, v204
    v_min_f32 v205, s48, v205
    v_exp_f32 v200, v200
    v_exp_f32 v201, v201
    v_exp_f32 v204, v204
    v_exp_f32 v205, v205
    v_pk_add_f32 v[202:203], v[200:201], s[56:57]
    v_pk_mul_f32 v[200:201], v[200:201], v[202:203]
    v_pk_add_f32 v[202:203], v[200:201], s[56:57]
    v_pk_add_f32 v[206:207], v[204:205], s[56:57]
    v_pk_mul_f32 v[204:205], v[204:205], v[206:207]
    v_pk_add_f32 v[206:207], v[204:205], s[56:57]
    v_rcp_f32 v202, v202
    v_rcp_f32 v203, v203
    v_rcp_f32 v206, v206
    v_rcp_f32 v207, v207
    v_pk_mul_f32 v[200:201], v[200:201], v[160:161]
    v_pk_mul_f32 v[160:161], v[200:201], v[202:203]
    v_cvt_pk_bf16_f32 v120, v160, v161
    v_pk_mul_f32 v[204:205], v[204:205], v[162:163]
    v_pk_mul_f32 v[162:163], v[204:205], v[206:207]
    v_cvt_pk_bf16_f32 v121, v162, v163
    s_add_u32 m0, s55, 131072
    s_add_u32 s45, s54, 655360
    buffer_load_dwordx4 v7, s[20:23], s45 offen lds
    s_add_u32 m0, s55, 139264
    s_add_u32 s45, s54, 720896
    buffer_load_dwordx4 v7, s[20:23], s45 offen lds
    s_waitcnt lgkmcnt(0)
    v_pk_add_f32 v[164:165], v[164:165], v[100:101]
    v_pk_fma_f32 v[164:165], v[68:69], v[192:193], v[164:165] op_sel_hi:[1,0,1] neg_lo:[0,1,0] neg_hi:[0,1,0]
    v_pk_fma_f32 v[164:165], v[164:165], v[196:197], v[44:45] op_sel_hi:[1,0,1]
    v_pk_mul_f32 v[200:201], v[164:165], s[42:43]
    v_min_f32 v200, s48, v200
    v_min_f32 v201, s48, v201
    v_pk_add_f32 v[166:167], v[166:167], v[102:103]
    v_pk_fma_f32 v[166:167], v[70:71], v[192:193], v[166:167] op_sel_hi:[1,0,1] neg_lo:[0,1,0] neg_hi:[0,1,0]
    v_pk_fma_f32 v[166:167], v[166:167], v[196:197], v[46:47] op_sel_hi:[1,0,1]
    v_pk_mul_f32 v[204:205], v[166:167], s[42:43]
    v_min_f32 v204, s48, v204
    v_min_f32 v205, s48, v205
    v_exp_f32 v200, v200
    v_exp_f32 v201, v201
    v_exp_f32 v204, v204
    v_exp_f32 v205, v205
    v_pk_add_f32 v[202:203], v[200:201], s[56:57]
    v_pk_mul_f32 v[200:201], v[200:201], v[202:203]
    v_pk_add_f32 v[202:203], v[200:201], s[56:57]
    v_pk_add_f32 v[206:207], v[204:205], s[56:57]
    v_pk_mul_f32 v[204:205], v[204:205], v[206:207]
    v_pk_add_f32 v[206:207], v[204:205], s[56:57]
    v_rcp_f32 v202, v202
    v_rcp_f32 v203, v203
    v_rcp_f32 v206, v206
    v_rcp_f32 v207, v207
    v_pk_mul_f32 v[200:201], v[200:201], v[164:165]
    v_pk_mul_f32 v[164:165], v[200:201], v[202:203]
    v_cvt_pk_bf16_f32 v122, v164, v165
    v_pk_mul_f32 v[204:205], v[204:205], v[166:167]
    v_pk_mul_f32 v[166:167], v[204:205], v[206:207]
    v_cvt_pk_bf16_f32 v123, v166, v167
    buffer_store_dwordx4 v[120:123], v5, s[28:31], s40 offen offset:2048 sc1
    s_waitcnt lgkmcnt(0)
    s_barrier
    s_add_u32 m0, s55, 147456
    s_add_u32 s45, s54, 786432
    buffer_load_dwordx4 v7, s[20:23], s45 offen lds
    s_add_u32 m0, s55, 155648
    s_add_u32 s45, s54, 851968
    buffer_load_dwordx4 v7, s[20:23], s45 offen lds
    s_add_u32 m0, s55, 0
    s_add_u32 s45, s54, 917504
    buffer_load_dwordx4 v7, s[20:23], s45 offen lds
    s_add_u32 m0, s55, 8192
    s_add_u32 s45, s54, 983040
    buffer_load_dwordx4 v7, s[20:23], s45 offen lds
    s_add_u32 m0, s55, 16384
    s_add_u32 s45, s54, 1048576
    buffer_load_dwordx4 v7, s[20:23], s45 offen lds
    s_add_u32 m0, s55, 24576
    s_add_u32 s45, s54, 1114112
    buffer_load_dwordx4 v7, s[20:23], s45 offen lds
    s_add_u32 m0, s55, 32768
    s_add_u32 s45, s54, 1179648
    buffer_load_dwordx4 v7, s[20:23], s45 offen lds
    s_add_u32 m0, s55, 40960
    s_add_u32 s45, s54, 1245184
    buffer_load_dwordx4 v7, s[20:23], s45 offen lds
    s_mov_b32 s24, s74
    s_and_b32 s25, s75, 0xffff
    s_mov_b32 s26, 2097152
    s_mov_b32 s27, 0x20000
    v_lshrrev_b32 v8, 2, v2
    v_and_b32 v9, 3, v1
    v_and_b32 v10, 1, v3
    v_xor_b32 v13, 0, v10
    v_lshl_add_u32 v12, v13, 2, v8
    v_lshl_add_u32 v12, v3, 3, v12
    v_lshlrev_b32 v12, 7, v12
    v_lshl_add_u32 v12, v13, 6, v12
    v_bfe_u32 v13, v2, 3, 1
    v_xor_b32 v13, v13, v9
    v_lshl_add_u32 v12, v13, 4, v12
    v_and_b32 v13, 1, v1
    v_lshl_add_u32 v12, v13, 3, v12
    v_xor_b32 v13, 8, v12
    v_xor_b32 v15, 1, v10
    v_lshl_add_u32 v14, v15, 2, v8
    v_lshl_add_u32 v14, v3, 3, v14
    v_lshlrev_b32 v14, 7, v14
    v_lshl_add_u32 v14, v15, 6, v14
    v_bfe_u32 v15, v2, 3, 1
    v_xor_b32 v15, v15, v9
    v_lshl_add_u32 v14, v15, 4, v14
    v_and_b32 v15, 1, v1
    v_lshl_add_u32 v14, v15, 3, v14
    v_xor_b32 v15, 8, v14
    s_and_b32 s60, s12, 1
    s_lshr_b32 s61, s12, 1
    s_lshl_b32 s41, s61, 12
    v_add_u32 v12, s41, v12
    v_add_u32 v16, 0x10000, v12
    v_add_u32 v20, 0x20000, v12
    v_add_u32 v13, s41, v13
    v_add_u32 v17, 0x10000, v13
    v_add_u32 v21, 0x20000, v13
    v_add_u32 v14, s41, v14
    v_add_u32 v18, 0x10000, v14
    v_add_u32 v22, 0x20000, v14
    v_add_u32 v15, s41, v15
    v_add_u32 v19, 0x10000, v15
    v_add_u32 v23, 0x20000, v15
    v_xor_b32 v176, 64, v12
    v_xor_b32 v177, 64, v13
    v_xor_b32 v178, 64, v14
    v_xor_b32 v179, 64, v15
    v_xor_b32 v180, 64, v16
    v_xor_b32 v181, 64, v17
    v_xor_b32 v182, 64, v18
    v_xor_b32 v183, 64, v19
    v_xor_b32 v184, 64, v20
    v_xor_b32 v185, 64, v21
    v_xor_b32 v186, 64, v22
    v_xor_b32 v187, 64, v23
    v_mov_b32 v24, 0
    v_mov_b32 v25, 0
    v_mov_b32 v26, 0
    v_mov_b32 v27, 0
    v_mov_b32 v28, 0
    v_mov_b32 v29, 0
    v_mov_b32 v30, 0
    v_mov_b32 v31, 0
    v_mov_b32 v32, 0
    v_mov_b32 v33, 0
    v_mov_b32 v34, 0
    v_mov_b32 v35, 0
    v_mov_b32 v36, 0
    v_mov_b32 v37, 0
    v_mov_b32 v38, 0
    v_mov_b32 v39, 0
    v_mov_b32 v40, 0
    v_mov_b32 v41, 0
    v_mov_b32 v42, 0
    v_mov_b32 v43, 0
    v_mov_b32 v44, 0
    v_mov_b32 v45, 0
    v_mov_b32 v46, 0
    v_mov_b32 v47, 0
    v_mov_b32 v48, 0
    v_mov_b32 v49, 0
    v_mov_b32 v50, 0
    v_mov_b32 v51, 0
    v_mov_b32 v52, 0
    v_mov_b32 v53, 0
    v_mov_b32 v54, 0
    v_mov_b32 v55, 0
    s_lshl_b32 s46, s13, 2
    s_lshl_b32 s41, s60, 1
    s_add_u32 s46, s46, s41
    s_mul_i32 s46, s46, 43
    s_add_u32 s46, s46, s61
    s_lshl_b32 s46, s46, 10
    s_add_u32 s46, s46, 4259840
    s_add_u32 s48, s46, 44032
    s_mov_b32 s32, s28
    s_mov_b32 s33, s29
    s_mov_b32 s35, s31
    s_cmp_lt_u32 s61, 3
    s_cselect_b32 s34, s30, 0
    s_add_u32 s47, s46, 0
    buffer_load_dwordx4 v[88:91], v5, s[28:31], s47 offen sc1
    s_add_u32 s47, s48, 0
    buffer_load_dwordx4 v[92:95], v5, s[28:31], s47 offen sc1
    s_add_u32 s47, s46, 4096
    buffer_load_dwordx4 v[96:99], v5, s[28:31], s47 offen sc1
    s_add_u32 s47, s48, 4096
    buffer_load_dwordx4 v[100:103], v5, s[28:31], s47 offen sc1
    s_add_u32 s47, s46, 8192
    buffer_load_dwordx4 v[104:107], v5, s[28:31], s47 offen sc1
    s_add_u32 s47, s48, 8192
    buffer_load_dwordx4 v[108:111], v5, s[28:31], s47 offen sc1
    s_add_u32 s47, s46, 12288
    buffer_load_dwordx4 v[112:115], v5, s[28:31], s47 offen sc1
    s_add_u32 s47, s48, 12288
    buffer_load_dwordx4 v[116:119], v5, s[28:31], s47 offen sc1
    s_waitcnt vmcnt(6)
    s_barrier
    ds_read_b64_tr_b16 v[56:57], v12 offset:49152
    ds_read_b64_tr_b16 v[58:59], v14 offset:49152
    ds_read_b64_tr_b16 v[60:61], v13 offset:49152
    ds_read_b64_tr_b16 v[62:63], v15 offset:49152
    ds_read_b64_tr_b16 v[64:65], v176 offset:49152
    ds_read_b64_tr_b16 v[66:67], v178 offset:49152
    ds_read_b64_tr_b16 v[68:69], v177 offset:49152
    ds_read_b64_tr_b16 v[70:71], v179 offset:49152
    s_waitcnt vmcnt(6)
P4A0_C:
    v_max3_u32 v10, v88, v89, v90
    v_max3_u32 v9, v91, v92, v93
    v_max3_u32 v10, v10, v94, v95
    v_max_u32 v10, v10, v9
    v_cmp_eq_u32 vcc, -1, v10
    s_cbranch_vccnz P4A0_R
P4A0_K:
    s_waitcnt lgkmcnt(6)
    v_mfma_f32_16x16x32_bf16 v[24:27], v[56:59], v[88:91], v[24:27]
    v_mfma_f32_16x16x32_bf16 v[40:43], v[56:59], v[92:95], v[40:43]
    ds_read_b64_tr_b16 v[72:73], v16 offset:0
    ds_read_b64_tr_b16 v[74:75], v18 offset:0
    s_add_u32 s47, s46, 16384
    buffer_load_dwordx4 v[120:123], v5, s[28:31], s47 offen sc1
    s_add_u32 s47, s48, 16384
    buffer_load_dwordx4 v[124:127], v5, s[28:31], s47 offen sc1
    s_waitcnt lgkmcnt(6)
    v_mfma_f32_16x16x32_bf16 v[28:31], v[60:63], v[88:91], v[28:31]
    v_mfma_f32_16x16x32_bf16 v[44:47], v[60:63], v[92:95], v[44:47]
    ds_read_b64_tr_b16 v[76:77], v17 offset:0
    ds_read_b64_tr_b16 v[78:79], v19 offset:0
    s_waitcnt lgkmcnt(6)
    v_mfma_f32_16x16x32_bf16 v[32:35], v[64:67], v[88:91], v[32:35]
    v_mfma_f32_16x16x32_bf16 v[48:51], v[64:67], v[92:95], v[48:51]
    ds_read_b64_tr_b16 v[80:81], v180 offset:0
    ds_read_b64_tr_b16 v[82:83], v182 offset:0
    s_add_u32 s47, s46, 20480
    buffer_load_dwordx4 v[128:131], v5, s[28:31], s47 offen sc1
    s_add_u32 s47, s48, 20480
    buffer_load_dwordx4 v[132:135], v5, s[28:31], s47 offen sc1
    s_waitcnt lgkmcnt(6)
    v_mfma_f32_16x16x32_bf16 v[36:39], v[68:71], v[88:91], v[36:39]
    v_mfma_f32_16x16x32_bf16 v[52:55], v[68:71], v[92:95], v[52:55]
    ds_read_b64_tr_b16 v[84:85], v181 offset:0
    ds_read_b64_tr_b16 v[86:87], v183 offset:0
    s_waitcnt vmcnt(8)
P4A1_C:
    v_max3_u32 v10, v96, v97, v98
    v_max3_u32 v9, v99, v100, v101
    v_max3_u32 v10, v10, v102, v103
    v_max_u32 v10, v10, v9
    v_cmp_eq_u32 vcc, -1, v10
    s_cbranch_vccnz P4A1_R
P4A1_K:
    s_waitcnt lgkmcnt(6)
    v_mfma_f32_16x16x32_bf16 v[24:27], v[72:75], v[96:99], v[24:27]
    v_mfma_f32_16x16x32_bf16 v[40:43], v[72:75], v[100:103], v[40:43]
    ds_read_b64_tr_b16 v[56:57], v16 offset:16384
    ds_read_b64_tr_b16 v[58:59], v18 offset:16384
    s_add_u32 s47, s46, 24576
    buffer_load_dwordx4 v[136:139], v5, s[28:31], s47 offen sc1
    s_add_u32 s47, s48, 24576
    buffer_load_dwordx4 v[140:143], v5, s[28:31], s47 offen sc1
    s_waitcnt lgkmcnt(6)
    v_mfma_f32_16x16x32_bf16 v[28:31], v[76:79], v[96:99], v[28:31]
    v_mfma_f32_16x16x32_bf16 v[44:47], v[76:79], v[100:103], v[44:47]
    ds_read_b64_tr_b16 v[60:61], v17 offset:16384
    ds_read_b64_tr_b16 v[62:63], v19 offset:16384
    s_waitcnt lgkmcnt(6)
    v_mfma_f32_16x16x32_bf16 v[32:35], v[80:83], v[96:99], v[32:35]
    v_mfma_f32_16x16x32_bf16 v[48:51], v[80:83], v[100:103], v[48:51]
    ds_read_b64_tr_b16 v[64:65], v180 offset:16384
    ds_read_b64_tr_b16 v[66:67], v182 offset:16384
    s_add_u32 s47, s46, 28672
    buffer_load_dwordx4 v[144:147], v5, s[28:31], s47 offen sc1
    s_add_u32 s47, s48, 28672
    buffer_load_dwordx4 v[148:151], v5, s[28:31], s47 offen sc1
    s_waitcnt lgkmcnt(6)
    v_mfma_f32_16x16x32_bf16 v[36:39], v[84:87], v[96:99], v[36:39]
    v_mfma_f32_16x16x32_bf16 v[52:55], v[84:87], v[100:103], v[52:55]
    ds_read_b64_tr_b16 v[68:69], v181 offset:16384
    ds_read_b64_tr_b16 v[70:71], v183 offset:16384
    s_waitcnt vmcnt(10)
P4A2_C:
    v_max3_u32 v10, v104, v105, v106
    v_max3_u32 v9, v107, v108, v109
    v_max3_u32 v10, v10, v110, v111
    v_max_u32 v10, v10, v9
    v_cmp_eq_u32 vcc, -1, v10
    s_cbranch_vccnz P4A2_R
P4A2_K:
    s_waitcnt lgkmcnt(6)
    v_mfma_f32_16x16x32_bf16 v[24:27], v[56:59], v[104:107], v[24:27]
    v_mfma_f32_16x16x32_bf16 v[40:43], v[56:59], v[108:111], v[40:43]
    ds_read_b64_tr_b16 v[72:73], v16 offset:32768
    ds_read_b64_tr_b16 v[74:75], v18 offset:32768
    s_add_u32 s47, s46, 32768
    buffer_load_dwordx4 v[152:155], v5, s[28:31], s47 offen sc1
    s_add_u32 s47, s48, 32768
    buffer_load_dwordx4 v[156:159], v5, s[28:31], s47 offen sc1
    s_waitcnt lgkmcnt(6)
    v_mfma_f32_16x16x32_bf16 v[28:31], v[60:63], v[104:107], v[28:31]
    v_mfma_f32_16x16x32_bf16 v[44:47], v[60:63], v[108:111], v[44:47]
    ds_read_b64_tr_b16 v[76:77], v17 offset:32768
    ds_read_b64_tr_b16 v[78:79], v19 offset:32768
    s_waitcnt lgkmcnt(6)
    v_mfma_f32_16x16x32_bf16 v[32:35], v[64:67], v[104:107], v[32:35]
    v_mfma_f32_16x16x32_bf16 v[48:51], v[64:67], v[108:111], v[48:51]
    ds_read_b64_tr_b16 v[80:81], v180 offset:32768
    ds_read_b64_tr_b16 v[82:83], v182 offset:32768
    s_add_u32 s47, s46, 36864
    buffer_load_dwordx4 v[160:163], v5, s[28:31], s47 offen sc1
    s_add_u32 s47, s48, 36864
    buffer_load_dwordx4 v[164:167], v5, s[28:31], s47 offen sc1
    s_waitcnt lgkmcnt(6)
    v_mfma_f32_16x16x32_bf16 v[36:39], v[68:71], v[104:107], v[36:39]
    v_mfma_f32_16x16x32_bf16 v[52:55], v[68:71], v[108:111], v[52:55]
    ds_read_b64_tr_b16 v[84:85], v181 offset:32768
    ds_read_b64_tr_b16 v[86:87], v183 offset:32768
    s_waitcnt vmcnt(12)
P4A3_C:
    v_max3_u32 v10, v112, v113, v114
    v_max3_u32 v9, v115, v116, v117
    v_max3_u32 v10, v10, v118, v119
    v_max_u32 v10, v10, v9
    v_cmp_eq_u32 vcc, -1, v10
    s_cbranch_vccnz P4A3_R
P4A3_K:
    s_waitcnt lgkmcnt(6)
    v_mfma_f32_16x16x32_bf16 v[24:27], v[72:75], v[112:115], v[24:27]
    v_mfma_f32_16x16x32_bf16 v[40:43], v[72:75], v[116:119], v[40:43]
    ds_read_b64_tr_b16 v[56:57], v16 offset:49152
    ds_read_b64_tr_b16 v[58:59], v18 offset:49152
    s_add_u32 s47, s46, 40960
    buffer_load_dwordx4 v[168:171], v5, s[32:35], s47 offen sc1
    s_add_u32 s47, s48, 40960
    buffer_load_dwordx4 v[172:175], v5, s[32:35], s47 offen sc1
    s_waitcnt lgkmcnt(6)
    v_mfma_f32_16x16x32_bf16 v[28:31], v[76:79], v[112:115], v[28:31]
    v_mfma_f32_16x16x32_bf16 v[44:47], v[76:79], v[116:119], v[44:47]
    ds_read_b64_tr_b16 v[60:61], v17 offset:49152
    ds_read_b64_tr_b16 v[62:63], v19 offset:49152
    s_waitcnt lgkmcnt(6)
    v_mfma_f32_16x16x32_bf16 v[32:35], v[80:83], v[112:115], v[32:35]
    v_mfma_f32_16x16x32_bf16 v[48:51], v[80:83], v[116:119], v[48:51]
    ds_read_b64_tr_b16 v[64:65], v180 offset:49152
    ds_read_b64_tr_b16 v[66:67], v182 offset:49152
    s_waitcnt lgkmcnt(6)
    v_mfma_f32_16x16x32_bf16 v[36:39], v[84:87], v[112:115], v[36:39]
    v_mfma_f32_16x16x32_bf16 v[52:55], v[84:87], v[116:119], v[52:55]
    ds_read_b64_tr_b16 v[68:69], v181 offset:49152
    ds_read_b64_tr_b16 v[70:71], v183 offset:49152
    s_waitcnt vmcnt(12)
P4A4_C:
    v_max3_u32 v10, v120, v121, v122
    v_max3_u32 v9, v123, v124, v125
    v_max3_u32 v10, v10, v126, v127
    v_max_u32 v10, v10, v9
    v_cmp_eq_u32 vcc, -1, v10
    s_cbranch_vccnz P4A4_R
P4A4_K:
    s_waitcnt lgkmcnt(6)
    v_mfma_f32_16x16x32_bf16 v[24:27], v[56:59], v[120:123], v[24:27]
    v_mfma_f32_16x16x32_bf16 v[40:43], v[56:59], v[124:127], v[40:43]
    ds_read_b64_tr_b16 v[72:73], v20 offset:0
    ds_read_b64_tr_b16 v[74:75], v22 offset:0
    s_waitcnt lgkmcnt(6)
    v_mfma_f32_16x16x32_bf16 v[28:31], v[60:63], v[120:123], v[28:31]
    v_mfma_f32_16x16x32_bf16 v[44:47], v[60:63], v[124:127], v[44:47]
    ds_read_b64_tr_b16 v[76:77], v21 offset:0
    ds_read_b64_tr_b16 v[78:79], v23 offset:0
    s_waitcnt lgkmcnt(6)
    v_mfma_f32_16x16x32_bf16 v[32:35], v[64:67], v[120:123], v[32:35]
    v_mfma_f32_16x16x32_bf16 v[48:51], v[64:67], v[124:127], v[48:51]
    ds_read_b64_tr_b16 v[80:81], v184 offset:0
    ds_read_b64_tr_b16 v[82:83], v186 offset:0
    s_waitcnt lgkmcnt(6)
    v_mfma_f32_16x16x32_bf16 v[36:39], v[68:71], v[120:123], v[36:39]
    v_mfma_f32_16x16x32_bf16 v[52:55], v[68:71], v[124:127], v[52:55]
    ds_read_b64_tr_b16 v[84:85], v185 offset:0
    ds_read_b64_tr_b16 v[86:87], v187 offset:0
    s_waitcnt vmcnt(10)
P4A5_C:
    v_max3_u32 v10, v128, v129, v130
    v_max3_u32 v9, v131, v132, v133
    v_max3_u32 v10, v10, v134, v135
    v_max_u32 v10, v10, v9
    v_cmp_eq_u32 vcc, -1, v10
    s_cbranch_vccnz P4A5_R
P4A5_K:
    s_waitcnt lgkmcnt(6)
    v_mfma_f32_16x16x32_bf16 v[24:27], v[72:75], v[128:131], v[24:27]
    v_mfma_f32_16x16x32_bf16 v[40:43], v[72:75], v[132:135], v[40:43]
    ds_read_b64_tr_b16 v[56:57], v20 offset:16384
    ds_read_b64_tr_b16 v[58:59], v22 offset:16384
    s_waitcnt lgkmcnt(6)
    v_mfma_f32_16x16x32_bf16 v[28:31], v[76:79], v[128:131], v[28:31]
    v_mfma_f32_16x16x32_bf16 v[44:47], v[76:79], v[132:135], v[44:47]
    ds_read_b64_tr_b16 v[60:61], v21 offset:16384
    ds_read_b64_tr_b16 v[62:63], v23 offset:16384
    s_waitcnt lgkmcnt(6)
    v_mfma_f32_16x16x32_bf16 v[32:35], v[80:83], v[128:131], v[32:35]
    v_mfma_f32_16x16x32_bf16 v[48:51], v[80:83], v[132:135], v[48:51]
    ds_read_b64_tr_b16 v[64:65], v184 offset:16384
    ds_read_b64_tr_b16 v[66:67], v186 offset:16384
    s_waitcnt lgkmcnt(6)
    v_mfma_f32_16x16x32_bf16 v[36:39], v[84:87], v[128:131], v[36:39]
    v_mfma_f32_16x16x32_bf16 v[52:55], v[84:87], v[132:135], v[52:55]
    ds_read_b64_tr_b16 v[68:69], v185 offset:16384
    ds_read_b64_tr_b16 v[70:71], v187 offset:16384
    s_barrier
    s_add_u32 m0, s55, 49152
    s_add_u32 s45, s54, 1310720
    buffer_load_dwordx4 v7, s[20:23], s45 offen lds
    s_add_u32 m0, s55, 57344
    s_add_u32 s45, s54, 1376256
    buffer_load_dwordx4 v7, s[20:23], s45 offen lds
    s_waitcnt vmcnt(10)
P4A6_C:
    v_max3_u32 v10, v136, v137, v138
    v_max3_u32 v9, v139, v140, v141
    v_max3_u32 v10, v10, v142, v143
    v_max_u32 v10, v10, v9
    v_cmp_eq_u32 vcc, -1, v10
    s_cbranch_vccnz P4A6_R
P4A6_K:
    s_waitcnt lgkmcnt(6)
    v_mfma_f32_16x16x32_bf16 v[24:27], v[56:59], v[136:139], v[24:27]
    v_mfma_f32_16x16x32_bf16 v[40:43], v[56:59], v[140:143], v[40:43]
    ds_read_b64_tr_b16 v[72:73], v12 offset:0
    ds_read_b64_tr_b16 v[74:75], v14 offset:0
    s_waitcnt lgkmcnt(6)
    v_mfma_f32_16x16x32_bf16 v[28:31], v[60:63], v[136:139], v[28:31]
    v_mfma_f32_16x16x32_bf16 v[44:47], v[60:63], v[140:143], v[44:47]
    ds_read_b64_tr_b16 v[76:77], v13 offset:0
    ds_read_b64_tr_b16 v[78:79], v15 offset:0
    s_waitcnt lgkmcnt(6)
    v_mfma_f32_16x16x32_bf16 v[32:35], v[64:67], v[136:139], v[32:35]
    v_mfma_f32_16x16x32_bf16 v[48:51], v[64:67], v[140:143], v[48:51]
    ds_read_b64_tr_b16 v[80:81], v176 offset:0
    ds_read_b64_tr_b16 v[82:83], v178 offset:0
    s_waitcnt lgkmcnt(6)
    v_mfma_f32_16x16x32_bf16 v[36:39], v[68:71], v[136:139], v[36:39]
    v_mfma_f32_16x16x32_bf16 v[52:55], v[68:71], v[140:143], v[52:55]
    ds_read_b64_tr_b16 v[84:85], v177 offset:0
    ds_read_b64_tr_b16 v[86:87], v179 offset:0
    s_waitcnt vmcnt(8)
P4A7_C:
    v_max3_u32 v10, v144, v145, v146
    v_max3_u32 v9, v147, v148, v149
    v_max3_u32 v10, v10, v150, v151
    v_max_u32 v10, v10, v9
    v_cmp_eq_u32 vcc, -1, v10
    s_cbranch_vccnz P4A7_R
P4A7_K:
    s_waitcnt lgkmcnt(6)
    v_mfma_f32_16x16x32_bf16 v[24:27], v[72:75], v[144:147], v[24:27]
    v_mfma_f32_16x16x32_bf16 v[40:43], v[72:75], v[148:151], v[40:43]
    ds_read_b64_tr_b16 v[56:57], v12 offset:16384
    ds_read_b64_tr_b16 v[58:59], v14 offset:16384
    s_waitcnt lgkmcnt(6)
    v_mfma_f32_16x16x32_bf16 v[28:31], v[76:79], v[144:147], v[28:31]
    v_mfma_f32_16x16x32_bf16 v[44:47], v[76:79], v[148:151], v[44:47]
    ds_read_b64_tr_b16 v[60:61], v13 offset:16384
    ds_read_b64_tr_b16 v[62:63], v15 offset:16384
    s_waitcnt lgkmcnt(6)
    v_mfma_f32_16x16x32_bf16 v[32:35], v[80:83], v[144:147], v[32:35]
    v_mfma_f32_16x16x32_bf16 v[48:51], v[80:83], v[148:151], v[48:51]
    ds_read_b64_tr_b16 v[64:65], v176 offset:16384
    ds_read_b64_tr_b16 v[66:67], v178 offset:16384
    s_waitcnt lgkmcnt(6)
    v_mfma_f32_16x16x32_bf16 v[36:39], v[84:87], v[144:147], v[36:39]
    v_mfma_f32_16x16x32_bf16 v[52:55], v[84:87], v[148:151], v[52:55]
    ds_read_b64_tr_b16 v[68:69], v177 offset:16384
    ds_read_b64_tr_b16 v[70:71], v179 offset:16384
    s_waitcnt vmcnt(6)
P4A8_C:
    v_max3_u32 v10, v152, v153, v154
    v_max3_u32 v9, v155, v156, v157
    v_max3_u32 v10, v10, v158, v159
    v_max_u32 v10, v10, v9
    v_cmp_eq_u32 vcc, -1, v10
    s_cbranch_vccnz P4A8_R
P4A8_K:
    s_waitcnt lgkmcnt(6)
    v_mfma_f32_16x16x32_bf16 v[24:27], v[56:59], v[152:155], v[24:27]
    v_mfma_f32_16x16x32_bf16 v[40:43], v[56:59], v[156:159], v[40:43]
    ds_read_b64_tr_b16 v[72:73], v12 offset:32768
    ds_read_b64_tr_b16 v[74:75], v14 offset:32768
    s_waitcnt lgkmcnt(6)
    v_mfma_f32_16x16x32_bf16 v[28:31], v[60:63], v[152:155], v[28:31]
    v_mfma_f32_16x16x32_bf16 v[44:47], v[60:63], v[156:159], v[44:47]
    ds_read_b64_tr_b16 v[76:77], v13 offset:32768
    ds_read_b64_tr_b16 v[78:79], v15 offset:32768
    s_waitcnt lgkmcnt(6)
    v_mfma_f32_16x16x32_bf16 v[32:35], v[64:67], v[152:155], v[32:35]
    v_mfma_f32_16x16x32_bf16 v[48:51], v[64:67], v[156:159], v[48:51]
    ds_read_b64_tr_b16 v[80:81], v176 offset:32768
    ds_read_b64_tr_b16 v[82:83], v178 offset:32768
    s_waitcnt lgkmcnt(6)
    v_mfma_f32_16x16x32_bf16 v[36:39], v[68:71], v[152:155], v[36:39]
    v_mfma_f32_16x16x32_bf16 v[52:55], v[68:71], v[156:159], v[52:55]
    ds_read_b64_tr_b16 v[84:85], v177 offset:32768
    ds_read_b64_tr_b16 v[86:87], v179 offset:32768
    s_waitcnt vmcnt(0)
    s_barrier
    s_waitcnt vmcnt(4)
P4A9_C:
    v_max3_u32 v10, v160, v161, v162
    v_max3_u32 v9, v163, v164, v165
    v_max3_u32 v10, v10, v166, v167
    v_max_u32 v10, v10, v9
    v_cmp_eq_u32 vcc, -1, v10
    s_cbranch_vccnz P4A9_R
P4A9_K:
    s_waitcnt lgkmcnt(6)
    v_mfma_f32_16x16x32_bf16 v[24:27], v[72:75], v[160:163], v[24:27]
    v_mfma_f32_16x16x32_bf16 v[40:43], v[72:75], v[164:167], v[40:43]
    ds_read_b64_tr_b16 v[56:57], v12 offset:49152
    ds_read_b64_tr_b16 v[58:59], v14 offset:49152
    s_waitcnt lgkmcnt(6)
    v_mfma_f32_16x16x32_bf16 v[28:31], v[76:79], v[160:163], v[28:31]
    v_mfma_f32_16x16x32_bf16 v[44:47], v[76:79], v[164:167], v[44:47]
    ds_read_b64_tr_b16 v[60:61], v13 offset:49152
    ds_read_b64_tr_b16 v[62:63], v15 offset:49152
    s_waitcnt lgkmcnt(6)
    v_mfma_f32_16x16x32_bf16 v[32:35], v[80:83], v[160:163], v[32:35]
    v_mfma_f32_16x16x32_bf16 v[48:51], v[80:83], v[164:167], v[48:51]
    ds_read_b64_tr_b16 v[64:65], v176 offset:49152
    ds_read_b64_tr_b16 v[66:67], v178 offset:49152
    s_waitcnt lgkmcnt(6)
    v_mfma_f32_16x16x32_bf16 v[36:39], v[84:87], v[160:163], v[36:39]
    v_mfma_f32_16x16x32_bf16 v[52:55], v[84:87], v[164:167], v[52:55]
    ds_read_b64_tr_b16 v[68:69], v177 offset:49152
    ds_read_b64_tr_b16 v[70:71], v179 offset:49152
    s_waitcnt vmcnt(2)
P4A10_C:
    v_max3_u32 v10, v168, v169, v170
    v_max3_u32 v9, v171, v172, v173
    v_max3_u32 v10, v10, v174, v175
    v_max_u32 v10, v10, v9
    v_cmp_eq_u32 vcc, -1, v10
    s_cbranch_vccnz P4A10_R
P4A10_K:
    s_waitcnt lgkmcnt(6)
    v_mfma_f32_16x16x32_bf16 v[24:27], v[56:59], v[168:171], v[24:27]
    v_mfma_f32_16x16x32_bf16 v[40:43], v[56:59], v[172:175], v[40:43]
    s_waitcnt lgkmcnt(4)
    v_mfma_f32_16x16x32_bf16 v[28:31], v[60:63], v[168:171], v[28:31]
    v_mfma_f32_16x16x32_bf16 v[44:47], v[60:63], v[172:175], v[44:47]
    s_waitcnt lgkmcnt(2)
    v_mfma_f32_16x16x32_bf16 v[32:35], v[64:67], v[168:171], v[32:35]
    v_mfma_f32_16x16x32_bf16 v[48:51], v[64:67], v[172:175], v[48:51]
    s_waitcnt lgkmcnt(0)
    v_mfma_f32_16x16x32_bf16 v[36:39], v[68:71], v[168:171], v[36:39]
    v_mfma_f32_16x16x32_bf16 v[52:55], v[68:71], v[172:175], v[52:55]
    s_lshl_b32 s40, s60, 15
    s_lshl_b32 s41, s61, 11
    s_add_u32 s40, s40, s41
    s_add_u32 s40, s40, 65536
    v_add_u32 v8, s40, v5
    ds_write_b128 v8, v[24:27] offset:0
    ds_write_b128 v8, v[28:31] offset:1024
    ds_write_b128 v8, v[32:35] offset:8192
    ds_write_b128 v8, v[36:39] offset:9216
    ds_write_b128 v8, v[40:43] offset:16384
    ds_write_b128 v8, v[44:47] offset:17408
    ds_write_b128 v8, v[48:51] offset:24576
    ds_write_b128 v8, v[52:55] offset:25600
    v_lshlrev_b32 v56, 16, v240
    v_and_b32 v57, 0xffff0000, v240
    v_lshlrev_b32 v58, 16, v241
    v_and_b32 v59, 0xffff0000, v241
    v_lshlrev_b32 v60, 16, v242
    v_and_b32 v61, 0xffff0000, v242
    v_lshlrev_b32 v62, 16, v243
    v_and_b32 v63, 0xffff0000, v243
    s_lshl_b32 s40, s18, 14
    s_lshl_b32 s41, s19, 13
    s_add_u32 s40, s40, s41
    s_add_u32 s40, s40, 65536
    v_add_u32 v8, s40, v5
    s_waitcnt lgkmcnt(0)
    s_barrier
    ds_read_b128 v[88:91], v8 offset:0
    ds_read_b128 v[92:95], v8 offset:1024
    ds_read_b128 v[96:99], v8 offset:2048
    ds_read_b128 v[100:103], v8 offset:3072
    ds_read_b128 v[104:107], v8 offset:4096
    ds_read_b128 v[108:111], v8 offset:5120
    ds_read_b128 v[112:115], v8 offset:6144
    ds_read_b128 v[116:119], v8 offset:7168
    s_lshl_b32 s41, s12, 10
    s_add_u32 s41, s41, 131072
    v_and_b32 v9, 1, v3
    v_lshlrev_b32 v9, 3, v9
    v_lshl_add_u32 v9, v3, 4, v9
    v_lshl_add_u32 v9, v2, 6, v9
    v_add_u32 v9, s41, v9
    v_xor_b32 v10, 8, v9
    v_add_u32 v52, s41, v5
    v_lshrrev_b32 v53, 2, v1
    v_and_b32 v54, 3, v1
    v_lshlrev_b32 v54, 4, v54
    v_lshl_add_u32 v53, v53, 10, v54
    s_lshl_b32 s40, s15, 14
    s_lshl_b32 s41, s14, 7
    s_add_u32 s40, s40, s41
    s_lshl_b32 s41, s19, 6
    s_add_u32 s40, s40, s41
    s_waitcnt lgkmcnt(6)
    v_pk_add_f32 v[56:57], v[56:57], v[88:89]
    v_pk_add_f32 v[58:59], v[58:59], v[90:91]
    v_pk_add_f32 v[60:61], v[60:61], v[92:93]
    v_pk_add_f32 v[62:63], v[62:63], v[94:95]
    s_waitcnt lgkmcnt(4)
    v_pk_add_f32 v[56:57], v[56:57], v[96:97]
    v_pk_add_f32 v[58:59], v[58:59], v[98:99]
    v_pk_add_f32 v[60:61], v[60:61], v[100:101]
    v_pk_add_f32 v[62:63], v[62:63], v[102:103]
    s_waitcnt lgkmcnt(2)
    v_pk_add_f32 v[56:57], v[56:57], v[104:105]
    v_pk_add_f32 v[58:59], v[58:59], v[106:107]
    v_pk_add_f32 v[60:61], v[60:61], v[108:109]
    v_pk_add_f32 v[62:63], v[62:63], v[110:111]
    s_waitcnt lgkmcnt(0)
    v_pk_add_f32 v[56:57], v[56:57], v[112:113]
    v_pk_add_f32 v[58:59], v[58:59], v[114:115]
    v_pk_add_f32 v[60:61], v[60:61], v[116:117]
    v_pk_add_f32 v[62:63], v[62:63], v[118:119]
    v_cvt_pk_bf16_f32 v48, v56, v57
    v_cvt_pk_bf16_f32 v49, v58, v59
    v_cvt_pk_bf16_f32 v50, v60, v61
    v_cvt_pk_bf16_f32 v51, v62, v63
    ds_write_b64 v9, v[48:49]
    ds_write_b64 v10, v[50:51]
    s_waitcnt lgkmcnt(0)
    ds_read_b128 v[64:67], v52
    s_waitcnt lgkmcnt(0)
    buffer_store_dwordx4 v[64:67], v53, s[24:27], s40 offen
    s_nop 1
KF_END:
    s_endpgm
P3A0_R:
    s_add_u32 s53, s53, 1
    s_cmp_gt_u32 s53, 0x40000
    s_cbranch_scc1 P3A0_K
    s_sleep 2
    s_add_u32 s47, s46, 0
    buffer_load_dwordx4 v[80:83], v5, s[28:31], s47 offen sc1
    s_add_u32 s47, s48, 0
    buffer_load_dwordx4 v[84:87], v5, s[28:31], s47 offen sc1
    s_waitcnt vmcnt(0)
    s_branch P3A0_C
P3A1_R:
    s_add_u32 s53, s53, 1
    s_cmp_gt_u32 s53, 0x40000
    s_cbranch_scc1 P3A1_K
    s_sleep 2
    s_add_u32 s47, s46, 2048
    buffer_load_dwordx4 v[88:91], v5, s[28:31], s47 offen sc1
    s_add_u32 s47, s48, 2048
    buffer_load_dwordx4 v[92:95], v5, s[28:31], s47 offen sc1
    s_waitcnt vmcnt(0)
    s_branch P3A1_C
P3A2_R:
    s_add_u32 s53, s53, 1
    s_cmp_gt_u32 s53, 0x40000
    s_cbranch_scc1 P3A2_K
    s_sleep 2
    s_add_u32 s47, s46, 4096
    buffer_load_dwordx4 v[96:99], v5, s[28:31], s47 offen sc1
    s_add_u32 s47, s48, 4096
    buffer_load_dwordx4 v[100:103], v5, s[28:31], s47 offen sc1
    s_waitcnt vmcnt(0)
    s_branch P3A2_C
P3A3_R:
    s_add_u32 s53, s53, 1
    s_cmp_gt_u32 s53, 0x40000
    s_cbranch_scc1 P3A3_K
    s_sleep 2
    s_add_u32 s47, s46, 6144
    buffer_load_dwordx4 v[104:107], v5, s[28:31], s47 offen sc1
    s_add_u32 s47, s48, 6144
    buffer_load_dwordx4 v[108:111], v5, s[28:31], s47 offen sc1
    s_waitcnt vmcnt(0)
    s_branch P3A3_C
P3A4_R:
    s_add_u32 s53, s53, 1
    s_cmp_gt_u32 s53, 0x40000
    s_cbranch_scc1 P3A4_K
    s_sleep 2
    s_add_u32 s47, s46, 8192
    buffer_load_dwordx4 v[112:115], v5, s[28:31], s47 offen sc1
    s_add_u32 s47, s48, 8192
    buffer_load_dwordx4 v[116:119], v5, s[28:31], s47 offen sc1
    s_waitcnt vmcnt(0)
    s_branch P3A4_C
P3A5_R:
    s_add_u32 s53, s53, 1
    s_cmp_gt_u32 s53, 0x40000
    s_cbranch_scc1 P3A5_K
    s_sleep 2
    s_add_u32 s47, s46, 10240
    buffer_load_dwordx4 v[120:123], v5, s[28:31], s47 offen sc1
    s_add_u32 s47, s48, 10240
    buffer_load_dwordx4 v[124:127], v5, s[28:31], s47 offen sc1
    s_waitcnt vmcnt(0)
    s_branch P3A5_C
P3A6_R:
    s_add_u32 s53, s53, 1
    s_cmp_gt_u32 s53, 0x40000
    s_cbranch_scc1 P3A6_K
    s_sleep 2
    s_add_u32 s47, s46, 12288
    buffer_load_dwordx4 v[128:131], v5, s[28:31], s47 offen sc1
    s_add_u32 s47, s48, 12288
    buffer_load_dwordx4 v[132:135], v5, s[28:31], s47 offen sc1
    s_waitcnt vmcnt(0)
    s_branch P3A6_C
P3A7_R:
    s_add_u32 s53, s53, 1
    s_cmp_gt_u32 s53, 0x40000
    s_cbranch_scc1 P3A7_K
    s_sleep 2
    s_add_u32 s47, s46, 14336
    buffer_load_dwordx4 v[136:139], v5, s[28:31], s47 offen sc1
    s_add_u32 s47, s48, 14336
    buffer_load_dwordx4 v[140:143], v5, s[28:31], s47 offen sc1
    s_waitcnt vmcnt(0)
    s_branch P3A7_C
P3S_R:
    s_add_u32 s53, s53, 1
    s_cmp_gt_u32 s53, 0x40000
    s_cbranch_scc1 P3S_K
    s_sleep 2
    s_lshl_b32 s44, s16, 11
    s_add_u32 s44, s44, 9895936
    buffer_load_dwordx4 v[72:75], v5, s[28:31], s44 offen sc1
    buffer_load_dwordx4 v[76:79], v5, s[28:31], s44 offen offset:1024 sc1
    s_waitcnt vmcnt(0)
    s_branch P3S_C
P4A0_R:
    s_add_u32 s53, s53, 1
    s_cmp_gt_u32 s53, 0x40000
    s_cbranch_scc1 P4A0_K
    s_sleep 2
    s_add_u32 s47, s46, 0
    buffer_load_dwordx4 v[88:91], v5, s[28:31], s47 offen sc1
    s_add_u32 s47, s48, 0
    buffer_load_dwordx4 v[92:95], v5, s[28:31], s47 offen sc1
    s_waitcnt vmcnt(0)
    s_branch P4A0_C
P4A1_R:
    s_add_u32 s53, s53, 1
    s_cmp_gt_u32 s53, 0x40000
    s_cbranch_scc1 P4A1_K
    s_sleep 2
    s_add_u32 s47, s46, 4096
    buffer_load_dwordx4 v[96:99], v5, s[28:31], s47 offen sc1
    s_add_u32 s47, s48, 4096
    buffer_load_dwordx4 v[100:103], v5, s[28:31], s47 offen sc1
    s_waitcnt vmcnt(0)
    s_branch P4A1_C
P4A2_R:
    s_add_u32 s53, s53, 1
    s_cmp_gt_u32 s53, 0x40000
    s_cbranch_scc1 P4A2_K
    s_sleep 2
    s_add_u32 s47, s46, 8192
    buffer_load_dwordx4 v[104:107], v5, s[28:31], s47 offen sc1
    s_add_u32 s47, s48, 8192
    buffer_load_dwordx4 v[108:111], v5, s[28:31], s47 offen sc1
    s_waitcnt vmcnt(0)
    s_branch P4A2_C
P4A3_R:
    s_add_u32 s53, s53, 1
    s_cmp_gt_u32 s53, 0x40000
    s_cbranch_scc1 P4A3_K
    s_sleep 2
    s_add_u32 s47, s46, 12288
    buffer_load_dwordx4 v[112:115], v5, s[28:31], s47 offen sc1
    s_add_u32 s47, s48, 12288
    buffer_load_dwordx4 v[116:119], v5, s[28:31], s47 offen sc1
    s_waitcnt vmcnt(0)
    s_branch P4A3_C
P4A4_R:
    s_add_u32 s53, s53, 1
    s_cmp_gt_u32 s53, 0x40000
    s_cbranch_scc1 P4A4_K
    s_sleep 2
    s_add_u32 s47, s46, 16384
    buffer_load_dwordx4 v[120:123], v5, s[28:31], s47 offen sc1
    s_add_u32 s47, s48, 16384
    buffer_load_dwordx4 v[124:127], v5, s[28:31], s47 offen sc1
    s_waitcnt vmcnt(0)
    s_branch P4A4_C
P4A5_R:
    s_add_u32 s53, s53, 1
    s_cmp_gt_u32 s53, 0x40000
    s_cbranch_scc1 P4A5_K
    s_sleep 2
    s_add_u32 s47, s46, 20480
    buffer_load_dwordx4 v[128:131], v5, s[28:31], s47 offen sc1
    s_add_u32 s47, s48, 20480
    buffer_load_dwordx4 v[132:135], v5, s[28:31], s47 offen sc1
    s_waitcnt vmcnt(0)
    s_branch P4A5_C
P4A6_R:
    s_add_u32 s53, s53, 1
    s_cmp_gt_u32 s53, 0x40000
    s_cbranch_scc1 P4A6_K
    s_sleep 2
    s_add_u32 s47, s46, 24576
    buffer_load_dwordx4 v[136:139], v5, s[28:31], s47 offen sc1
    s_add_u32 s47, s48, 24576
    buffer_load_dwordx4 v[140:143], v5, s[28:31], s47 offen sc1
    s_waitcnt vmcnt(0)
    s_branch P4A6_C
P4A7_R:
    s_add_u32 s53, s53, 1
    s_cmp_gt_u32 s53, 0x40000
    s_cbranch_scc1 P4A7_K
    s_sleep 2
    s_add_u32 s47, s46, 28672
    buffer_load_dwordx4 v[144:147], v5, s[28:31], s47 offen sc1
    s_add_u32 s47, s48, 28672
    buffer_load_dwordx4 v[148:151], v5, s[28:31], s47 offen sc1
    s_waitcnt vmcnt(0)
    s_branch P4A7_C
P4A8_R:
    s_add_u32 s53, s53, 1
    s_cmp_gt_u32 s53, 0x40000
    s_cbranch_scc1 P4A8_K
    s_sleep 2
    s_add_u32 s47, s46, 32768
    buffer_load_dwordx4 v[152:155], v5, s[28:31], s47 offen sc1
    s_add_u32 s47, s48, 32768
    buffer_load_dwordx4 v[156:159], v5, s[28:31], s47 offen sc1
    s_waitcnt vmcnt(0)
    s_branch P4A8_C
P4A9_R:
    s_add_u32 s53, s53, 1
    s_cmp_gt_u32 s53, 0x40000
    s_cbranch_scc1 P4A9_K
    s_sleep 2
    s_add_u32 s47, s46, 36864
    buffer_load_dwordx4 v[160:163], v5, s[28:31], s47 offen sc1
    s_add_u32 s47, s48, 36864
    buffer_load_dwordx4 v[164:167], v5, s[28:31], s47 offen sc1
    s_waitcnt vmcnt(0)
    s_branch P4A9_C
P4A10_R:
    s_add_u32 s53, s53, 1
    s_cmp_gt_u32 s53, 0x40000
    s_cbranch_scc1 P4A10_K
    s_sleep 2
    s_add_u32 s47, s46, 40960
    buffer_load_dwordx4 v[168:171], v5, s[32:35], s47 offen sc1
    s_add_u32 s47, s48, 40960
    buffer_load_dwordx4 v[172:175], v5, s[32:35], s47 offen sc1
    s_waitcnt vmcnt(0)
    s_branch P4A10_C
.section .rodata,"a"
.p2align 6
.amdhsa_kernel sequential_preLN__linear_attn_block__dense_activation_mish__prompt_kernel
  .amdhsa_next_free_vgpr 254
  .amdhsa_next_free_sgpr 102
  .amdhsa_accum_offset 256
  .amdhsa_group_segment_fixed_size 0
  .amdhsa_kernarg_size 80
  .amdhsa_user_sgpr_count 2
  .amdhsa_user_sgpr_kernarg_segment_ptr 1
  .amdhsa_system_sgpr_workgroup_id_x 1
.end_amdhsa_kernel
```
